```python
import torch

def _softmax(x, axis=-1):
    return torch.softmax(x, dim=axis)
def _gelu(x):
    return torch.nn.functional.gelu(x, approximate="tanh")
def _silu(x):
    return torch.nn.functional.silu(x)
def _sigmoid(x):
    return torch.sigmoid(x)
def _layernorm(x, axis=-1, eps=1e-5):
    m = x.mean(dim=axis, keepdim=True)
    v = x.var(dim=axis, keepdim=True, unbiased=False)
    return (x - m) / torch.sqrt(v + eps)
def _scatter_add(tgt, idx, src, axis=0):
    return tgt.clone().index_add_(axis, idx, src)
def _segment_sum(src, seg, n):
    out = torch.zeros((n,) + src.shape[1:], dtype=src.dtype)
    return out.index_add_(0, seg, src)
def _pad(x, pw):
    flat = tuple(v for pair in reversed(pw) for v in pair)
    return torch.nn.functional.pad(x, flat)

kernel_name = 'interleave_layers__sliding_block__glu_gated_bilinear__prompt'

def setup_inputs():

    _w = (lambda a: (lambda t: t.to(torch.bfloat16) if t.is_floating_point() else t)(torch.as_tensor(a)))
    def _A_setup():
        B, S, D = 1, 2048, 448
        return {
            "x": _w((lambda *s: torch.randn(*s, dtype=torch.bfloat16) * 0.05)(B, S, D)),
            "wqkv": _w((lambda *s: torch.randn(*s, dtype=torch.bfloat16) * 0.05)(D, 3 * D)),
            "wo": _w((lambda *s: torch.randn(*s, dtype=torch.bfloat16) * 0.05)(D, D)),
        }
    _A_in = _A_setup()

    def _B_setup():
        B, S, D, F = 1, 2048, 448, 1792
        return {
            "x": _w((lambda *s: torch.randn(*s, dtype=torch.bfloat16) * 0.05)(B, S, D)),
            "w_gate": _w((lambda *s: torch.randn(*s, dtype=torch.bfloat16) * 0.8)(D, F) * (D ** -0.5)),
            "w_up": _w((lambda *s: torch.randn(*s, dtype=torch.bfloat16) * 0.8)(D, F) * (D ** -0.5)),
            "w_down": _w((lambda *s: torch.randn(*s, dtype=torch.bfloat16) * 0.8)(F, D) * (F ** -0.5)),
        }
    _B_in = _B_setup()

    return {
        "A_x": _A_in["x"],
        "A_wqkv": _A_in["wqkv"],
        "A_wo": _A_in["wo"],
        "B_x": _B_in["x"],
        "B_w_gate": _B_in["w_gate"],
        "B_w_up": _B_in["w_up"],
        "B_w_down": _B_in["w_down"],
    }

def reference(A_x, A_wqkv, A_wo, B_x, B_w_gate, B_w_up, B_w_down):
    def _A_ref(x, wqkv, wo):
        B, S, D = x.shape
        H = 16; Dh = D // H; W = 256
        qkv = (lambda x, *d: x.permute(*d))((x @ wqkv).reshape(B, S, 3, H, Dh), 2, 0, 3, 1, 4)
        q, k, v = qkv[0], qkv[1], qkv[2]
        scores = torch.einsum("bhqd,bhkd->bhqk", q, k) * (Dh ** -0.5)
        idx = torch.arange(S)
        mask = (idx[:, None] - idx[None, :] >= 0) & (idx[:, None] - idx[None, :] < W)
        scores = torch.where(mask[None, None], scores, -1e9)
        p = _softmax(scores, axis=-1)
        o = torch.einsum("bhqk,bhkd->bhqd", p, v)
        return (lambda x, *d: x.permute(*d))(o, 0, 2, 1, 3).reshape(B, S, D) @ wo

    def _B_ref(x, w_gate, w_up, w_down):
        g = torch.einsum("bsd,df->bsf", x, w_gate)
        u = torch.einsum("bsd,df->bsf", x, w_up)
        h = g * u
        return torch.einsum("bsf,fd->bsd", h, w_down)

    x = A_x
    x = x + _A_ref(_layernorm(x, axis=-1), A_wqkv, A_wo)
    x = x + _B_ref(_layernorm(x, axis=-1), B_w_gate, B_w_up, B_w_down)
    x = x + _A_ref(_layernorm(x, axis=-1), A_wqkv, A_wo)
    x = x + _B_ref(_layernorm(x, axis=-1), B_w_gate, B_w_up, B_w_down)
    return x
```

```asm
; @launch kernel=prep_kernel grid=(147,1,1) block=(256,1,1) lds=66560
; @launch kernel=qa_kernel grid=(256,1,1) block=(512,1,1) lds=151552
; @launch kernel=ffn_kernel grid=(224,1,1) block=(256,1,1) lds=115712
; @launch kernel=qa_kernel grid=(256,1,1) block=(512,1,1) lds=151552
; @launch kernel=ffn_kernel grid=(224,1,1) block=(256,1,1) lds=115712
.amdgcn_target "amdgcn-amd-amdhsa--gfx950"
.text
.globl prep_kernel
.p2align 8
.type prep_kernel,@function
prep_kernel:
    s_cmp_ge_u32 s2, 147
    s_cbranch_scc1 prep_done
    s_load_dwordx4 s[4:7], s[0:1], 8
    s_load_dwordx4 s[12:15], s[0:1], 32
    s_load_dwordx2 s[16:17], s[0:1], 48
    s_load_dwordx2 s[18:19], s[0:1], 72
    s_load_dwordx2 s[48:49], s[0:1], 0
    v_lshrrev_b32 v1, 6, v0
    v_and_b32 v0, 63, v0
    s_nop 0
    v_readfirstlane_b32 s3, v1
    v_lshrrev_b32 v2, 4, v0
    v_and_b32 v3, 15, v0
    v_lshlrev_b32 v4, 4, v0
    v_mov_b32 v9, 0x3f803f80
    s_lshl_b32 s50, s3, 14
    v_lshrrev_b32 v10, 2, v3
    v_lshlrev_b32 v10, 7, v10
    v_and_b32 v11, 3, v3
    v_lshl_add_u32 v10, v11, 3, v10
    v_add_u32 v10, s50, v10
    v_lshrrev_b32 v12, 3, v0
    v_and_b32 v13, 7, v0
    s_waitcnt lgkmcnt(0)
    s_mov_b32 s24, s18
    s_mov_b32 s25, s19
    s_mov_b32 s26, 0x1000000
    s_mov_b32 s27, 0x20000
    s_cmp_lt_u32 s2, 24
    s_cbranch_scc1 prep_qkv
    s_cmp_lt_u32 s2, 80
    s_cbranch_scc1 prep_gu
    s_cmp_lt_u32 s2, 108
    s_cbranch_scc1 prep_wd
    s_cmp_lt_u32 s2, 115
    s_cbranch_scc1 prep_wo
    v_lshlrev_b32 v5, 8, v0
    v_mov_b32 v6, 0
    s_mov_b32 s40, 0x9f0000
    buffer_store_dword v6, v5, s[24:27], s40 offen
    v_lshlrev_b32 v5, 6, v0
    s_mov_b32 s40, 0x9e0000
    buffer_store_dword v6, v5, s[24:27], s40 offen
    s_mov_b32 s40, 0x9e1000
    buffer_store_dword v6, v5, s[24:27], s40 offen
    s_mov_b32 s40, 0x9e2000
    buffer_store_dword v6, v5, s[24:27], s40 offen
    s_mov_b32 s40, 0x9e3000
    buffer_store_dword v6, v5, s[24:27], s40 offen
    s_mov_b32 s40, 0x9e4000
    buffer_store_dword v6, v5, s[24:27], s40 offen
    s_mov_b32 s40, 0x9e5000
    buffer_store_dword v6, v5, s[24:27], s40 offen
    s_mov_b32 s40, 0x9e6000
    buffer_store_dword v6, v5, s[24:27], s40 offen
    s_mov_b32 s40, 0x9e7000
    buffer_store_dword v6, v5, s[24:27], s40 offen
    s_mov_b32 s28, s48
    s_mov_b32 s29, s49
    s_mov_b32 s30, 0x1c0000
    s_mov_b32 s31, 0x20000
    s_add_u32 s24, s18, 0x1e00000
    s_addc_u32 s25, s19, 0
    s_mov_b32 s26, 0x1c0000
    s_mov_b32 s27, 0x20000
    s_sub_u32 s40, s2, 115
    s_lshl_b32 s40, s40, 2
    s_add_u32 s40, s40, s3
    v_mul_u32_u24 v5, 896, v3
    v_lshl_add_u32 v5, v2, 4, v5
    s_mul_i32 s41, s40, 14336
    buffer_load_dwordx4 v[16:19], v5, s[28:31], s41 offen offset:0
    buffer_load_dwordx4 v[20:23], v5, s[28:31], s41 offen offset:64
    buffer_load_dwordx4 v[24:27], v5, s[28:31], s41 offen offset:128
    buffer_load_dwordx4 v[28:31], v5, s[28:31], s41 offen offset:192
    buffer_load_dwordx4 v[32:35], v5, s[28:31], s41 offen offset:256
    buffer_load_dwordx4 v[36:39], v5, s[28:31], s41 offen offset:320
    buffer_load_dwordx4 v[40:43], v5, s[28:31], s41 offen offset:384
    buffer_load_dwordx4 v[44:47], v5, s[28:31], s41 offen offset:448
    buffer_load_dwordx4 v[48:51], v5, s[28:31], s41 offen offset:512
    buffer_load_dwordx4 v[52:55], v5, s[28:31], s41 offen offset:576
    buffer_load_dwordx4 v[56:59], v5, s[28:31], s41 offen offset:640
    buffer_load_dwordx4 v[60:63], v5, s[28:31], s41 offen offset:704
    buffer_load_dwordx4 v[64:67], v5, s[28:31], s41 offen offset:768
    buffer_load_dwordx4 v[68:71], v5, s[28:31], s41 offen offset:832
    s_waitcnt vmcnt(13)
    s_add_u32 s42, s41, 0
    buffer_store_dwordx4 v[16:19], v4, s[24:27], s42 offen
    s_waitcnt vmcnt(13)
    s_add_u32 s42, s41, 1024
    buffer_store_dwordx4 v[20:23], v4, s[24:27], s42 offen
    s_waitcnt vmcnt(13)
    s_add_u32 s42, s41, 2048
    buffer_store_dwordx4 v[24:27], v4, s[24:27], s42 offen
    s_waitcnt vmcnt(13)
    s_add_u32 s42, s41, 3072
    buffer_store_dwordx4 v[28:31], v4, s[24:27], s42 offen
    s_waitcnt vmcnt(13)
    s_add_u32 s42, s41, 4096
    buffer_store_dwordx4 v[32:35], v4, s[24:27], s42 offen
    s_waitcnt vmcnt(13)
    s_add_u32 s42, s41, 5120
    buffer_store_dwordx4 v[36:39], v4, s[24:27], s42 offen
    s_waitcnt vmcnt(13)
    s_add_u32 s42, s41, 6144
    buffer_store_dwordx4 v[40:43], v4, s[24:27], s42 offen
    s_waitcnt vmcnt(13)
    s_add_u32 s42, s41, 7168
    buffer_store_dwordx4 v[44:47], v4, s[24:27], s42 offen
    s_waitcnt vmcnt(13)
    s_add_u32 s42, s41, 8192
    buffer_store_dwordx4 v[48:51], v4, s[24:27], s42 offen
    s_waitcnt vmcnt(13)
    s_add_u32 s42, s41, 9216
    buffer_store_dwordx4 v[52:55], v4, s[24:27], s42 offen
    s_waitcnt vmcnt(13)
    s_add_u32 s42, s41, 10240
    buffer_store_dwordx4 v[56:59], v4, s[24:27], s42 offen
    s_waitcnt vmcnt(13)
    s_add_u32 s42, s41, 11264
    buffer_store_dwordx4 v[60:63], v4, s[24:27], s42 offen
    s_waitcnt vmcnt(13)
    s_add_u32 s42, s41, 12288
    buffer_store_dwordx4 v[64:67], v4, s[24:27], s42 offen
    s_waitcnt vmcnt(13)
    s_add_u32 s42, s41, 13312
    buffer_store_dwordx4 v[68:71], v4, s[24:27], s42 offen
    s_endpgm
prep_qkv:
    s_mov_b32 s28, s4
    s_mov_b32 s29, s5
    s_mov_b32 s30, 0x126000
    s_mov_b32 s31, 0x20000
    s_mov_b32 s47, 0
    s_mov_b32 s46, s2
    s_lshr_b32 s40, s46, 3
    s_and_b32 s41, s46, 7
    s_mul_i32 s21, s46, 112
    s_mul_i32 s43, s47, 602112
    s_add_u32 s21, s21, s43
    s_mul_i32 s42, s41, 12
    s_lshl_b32 s43, s40, 2
    s_add_u32 s42, s42, s43
    s_mul_i32 s22, s42, 14336
    s_mul_i32 s43, s47, 7168
    s_add_u32 s22, s22, s43
    s_add_u32 s22, s22, 0x0
    s_lshl_b32 s23, s42, 6
    s_mul_i32 s43, s47, 32768
    s_add_u32 s23, s23, s43
    s_cmp_eq_u32 s40, 1
    s_cselect_b32 s43, 0x3f803f80, 0
    v_cmp_eq_u32 vcc, 12, v3
    v_mov_b32 v14, s43
    s_nop 1
    v_cndmask_b32 v14, 0, v14, vcc
    v_mul_u32_u24 v5, 2688, v12
    v_lshl_add_u32 v5, v13, 4, v5
    s_mul_i32 s40, s3, 86016
    s_add_u32 s40, s40, s21
    v_lshlrev_b32 v6, 10, v2
    v_add_u32 v6, v6, v10
    v_mov_b32 v80, 0
    v_mov_b32 v81, 0
    v_mov_b32 v82, 0
    v_mov_b32 v83, 0
    v_cmp_gt_u32 s[44:45], 12, v3
    s_add_u32 m0, s50, 0
    s_add_u32 s41, s40, 0
    buffer_load_dwordx4 v5, s[28:31], s41 offen lds
    s_add_u32 m0, s50, 1024
    s_add_u32 s41, s40, 21504
    buffer_load_dwordx4 v5, s[28:31], s41 offen lds
    s_add_u32 m0, s50, 2048
    s_add_u32 s41, s40, 43008
    buffer_load_dwordx4 v5, s[28:31], s41 offen lds
    s_add_u32 m0, s50, 3072
    s_add_u32 s41, s40, 64512
    buffer_load_dwordx4 v5, s[28:31], s41 offen lds
    s_add_u32 m0, s50, 4096
    s_add_u32 s41, s40, 344064
    buffer_load_dwordx4 v5, s[28:31], s41 offen lds
    s_add_u32 m0, s50, 5120
    s_add_u32 s41, s40, 365568
    buffer_load_dwordx4 v5, s[28:31], s41 offen lds
    s_add_u32 m0, s50, 6144
    s_add_u32 s41, s40, 387072
    buffer_load_dwordx4 v5, s[28:31], s41 offen lds
    s_add_u32 m0, s50, 7168
    s_add_u32 s41, s40, 408576
    buffer_load_dwordx4 v5, s[28:31], s41 offen lds
    s_add_u32 m0, s50, 8192
    s_add_u32 s41, s40, 688128
    buffer_load_dwordx4 v5, s[28:31], s41 offen lds
    s_add_u32 m0, s50, 9216
    s_add_u32 s41, s40, 709632
    buffer_load_dwordx4 v5, s[28:31], s41 offen lds
    s_add_u32 m0, s50, 10240
    s_add_u32 s41, s40, 731136
    buffer_load_dwordx4 v5, s[28:31], s41 offen lds
    s_add_u32 m0, s50, 11264
    s_add_u32 s41, s40, 752640
    buffer_load_dwordx4 v5, s[28:31], s41 offen lds
    s_cmp_ge_u32 s3, 2
    s_cbranch_scc1 pq_ld3
    s_add_u32 m0, s50, 12288
    s_add_u32 s41, s40, 1032192
    buffer_load_dwordx4 v5, s[28:31], s41 offen lds
    s_add_u32 m0, s50, 13312
    s_add_u32 s41, s40, 1053696
    buffer_load_dwordx4 v5, s[28:31], s41 offen lds
    s_add_u32 m0, s50, 14336
    s_add_u32 s41, s40, 1075200
    buffer_load_dwordx4 v5, s[28:31], s41 offen lds
    s_add_u32 m0, s50, 15360
    s_add_u32 s41, s40, 1096704
    buffer_load_dwordx4 v5, s[28:31], s41 offen lds
pq_ld3:
    s_waitcnt vmcnt(0)
    s_lshl_b32 s42, s3, 10
    s_add_u32 s42, s42, s22
    ds_read_b64_tr_b16 v[16:17], v6 offset:0
    ds_read_b64_tr_b16 v[18:19], v6 offset:512
    ds_read_b64_tr_b16 v[20:21], v6 offset:32
    ds_read_b64_tr_b16 v[22:23], v6 offset:544
    ds_read_b64_tr_b16 v[24:25], v6 offset:56
    ds_read_b64_tr_b16 v[26:27], v6 offset:568
    ds_read_b64_tr_b16 v[28:29], v6 offset:88
    ds_read_b64_tr_b16 v[30:31], v6 offset:600
    s_waitcnt lgkmcnt(6)
    v_dot2_f32_bf16 v80, v16, v9, v80
    v_dot2_f32_bf16 v80, v17, v9, v80
    v_dot2_f32_bf16 v80, v18, v9, v80
    v_dot2_f32_bf16 v80, v19, v9, v80
    s_add_u32 s43, s42, 0
    buffer_store_dwordx4 v[16:19], v4, s[24:27], s43 offen
    s_waitcnt lgkmcnt(4)
    v_cndmask_b32 v20, v14, v20, s[44:45]
    v_cndmask_b32 v21, v14, v21, s[44:45]
    v_cndmask_b32 v22, v14, v22, s[44:45]
    v_cndmask_b32 v23, v14, v23, s[44:45]
    v_dot2_f32_bf16 v81, v20, v9, v81
    v_dot2_f32_bf16 v81, v21, v9, v81
    v_dot2_f32_bf16 v81, v22, v9, v81
    v_dot2_f32_bf16 v81, v23, v9, v81
    s_add_u32 s43, s42, 14336
    buffer_store_dwordx4 v[20:23], v4, s[24:27], s43 offen
    s_waitcnt lgkmcnt(2)
    v_dot2_f32_bf16 v82, v24, v9, v82
    v_dot2_f32_bf16 v82, v25, v9, v82
    v_dot2_f32_bf16 v82, v26, v9, v82
    v_dot2_f32_bf16 v82, v27, v9, v82
    s_add_u32 s43, s42, 28672
    buffer_store_dwordx4 v[24:27], v4, s[24:27], s43 offen
    s_waitcnt lgkmcnt(0)
    v_cndmask_b32 v28, v14, v28, s[44:45]
    v_cndmask_b32 v29, v14, v29, s[44:45]
    v_cndmask_b32 v30, v14, v30, s[44:45]
    v_cndmask_b32 v31, v14, v31, s[44:45]
    v_dot2_f32_bf16 v83, v28, v9, v83
    v_dot2_f32_bf16 v83, v29, v9, v83
    v_dot2_f32_bf16 v83, v30, v9, v83
    v_dot2_f32_bf16 v83, v31, v9, v83
    s_add_u32 s43, s42, 43008
    buffer_store_dwordx4 v[28:31], v4, s[24:27], s43 offen
    ds_read_b64_tr_b16 v[32:33], v6 offset:4096
    ds_read_b64_tr_b16 v[34:35], v6 offset:4608
    ds_read_b64_tr_b16 v[36:37], v6 offset:4128
    ds_read_b64_tr_b16 v[38:39], v6 offset:4640
    ds_read_b64_tr_b16 v[40:41], v6 offset:4152
    ds_read_b64_tr_b16 v[42:43], v6 offset:4664
    ds_read_b64_tr_b16 v[44:45], v6 offset:4184
    ds_read_b64_tr_b16 v[46:47], v6 offset:4696
    s_waitcnt lgkmcnt(6)
    v_dot2_f32_bf16 v80, v32, v9, v80
    v_dot2_f32_bf16 v80, v33, v9, v80
    v_dot2_f32_bf16 v80, v34, v9, v80
    v_dot2_f32_bf16 v80, v35, v9, v80
    s_add_u32 s43, s42, 4096
    buffer_store_dwordx4 v[32:35], v4, s[24:27], s43 offen
    s_waitcnt lgkmcnt(4)
    v_cndmask_b32 v36, v14, v36, s[44:45]
    v_cndmask_b32 v37, v14, v37, s[44:45]
    v_cndmask_b32 v38, v14, v38, s[44:45]
    v_cndmask_b32 v39, v14, v39, s[44:45]
    v_dot2_f32_bf16 v81, v36, v9, v81
    v_dot2_f32_bf16 v81, v37, v9, v81
    v_dot2_f32_bf16 v81, v38, v9, v81
    v_dot2_f32_bf16 v81, v39, v9, v81
    s_add_u32 s43, s42, 18432
    buffer_store_dwordx4 v[36:39], v4, s[24:27], s43 offen
    s_waitcnt lgkmcnt(2)
    v_dot2_f32_bf16 v82, v40, v9, v82
    v_dot2_f32_bf16 v82, v41, v9, v82
    v_dot2_f32_bf16 v82, v42, v9, v82
    v_dot2_f32_bf16 v82, v43, v9, v82
    s_add_u32 s43, s42, 32768
    buffer_store_dwordx4 v[40:43], v4, s[24:27], s43 offen
    s_waitcnt lgkmcnt(0)
    v_cndmask_b32 v44, v14, v44, s[44:45]
    v_cndmask_b32 v45, v14, v45, s[44:45]
    v_cndmask_b32 v46, v14, v46, s[44:45]
    v_cndmask_b32 v47, v14, v47, s[44:45]
    v_dot2_f32_bf16 v83, v44, v9, v83
    v_dot2_f32_bf16 v83, v45, v9, v83
    v_dot2_f32_bf16 v83, v46, v9, v83
    v_dot2_f32_bf16 v83, v47, v9, v83
    s_add_u32 s43, s42, 47104
    buffer_store_dwordx4 v[44:47], v4, s[24:27], s43 offen
    ds_read_b64_tr_b16 v[48:49], v6 offset:8192
    ds_read_b64_tr_b16 v[50:51], v6 offset:8704
    ds_read_b64_tr_b16 v[52:53], v6 offset:8224
    ds_read_b64_tr_b16 v[54:55], v6 offset:8736
    ds_read_b64_tr_b16 v[56:57], v6 offset:8248
    ds_read_b64_tr_b16 v[58:59], v6 offset:8760
    ds_read_b64_tr_b16 v[60:61], v6 offset:8280
    ds_read_b64_tr_b16 v[62:63], v6 offset:8792
    s_waitcnt lgkmcnt(6)
    v_dot2_f32_bf16 v80, v48, v9, v80
    v_dot2_f32_bf16 v80, v49, v9, v80
    v_dot2_f32_bf16 v80, v50, v9, v80
    v_dot2_f32_bf16 v80, v51, v9, v80
    s_add_u32 s43, s42, 8192
    buffer_store_dwordx4 v[48:51], v4, s[24:27], s43 offen
    s_waitcnt lgkmcnt(4)
    v_cndmask_b32 v52, v14, v52, s[44:45]
    v_cndmask_b32 v53, v14, v53, s[44:45]
    v_cndmask_b32 v54, v14, v54, s[44:45]
    v_cndmask_b32 v55, v14, v55, s[44:45]
    v_dot2_f32_bf16 v81, v52, v9, v81
    v_dot2_f32_bf16 v81, v53, v9, v81
    v_dot2_f32_bf16 v81, v54, v9, v81
    v_dot2_f32_bf16 v81, v55, v9, v81
    s_add_u32 s43, s42, 22528
    buffer_store_dwordx4 v[52:55], v4, s[24:27], s43 offen
    s_waitcnt lgkmcnt(2)
    v_dot2_f32_bf16 v82, v56, v9, v82
    v_dot2_f32_bf16 v82, v57, v9, v82
    v_dot2_f32_bf16 v82, v58, v9, v82
    v_dot2_f32_bf16 v82, v59, v9, v82
    s_add_u32 s43, s42, 36864
    buffer_store_dwordx4 v[56:59], v4, s[24:27], s43 offen
    s_waitcnt lgkmcnt(0)
    v_cndmask_b32 v60, v14, v60, s[44:45]
    v_cndmask_b32 v61, v14, v61, s[44:45]
    v_cndmask_b32 v62, v14, v62, s[44:45]
    v_cndmask_b32 v63, v14, v63, s[44:45]
    v_dot2_f32_bf16 v83, v60, v9, v83
    v_dot2_f32_bf16 v83, v61, v9, v83
    v_dot2_f32_bf16 v83, v62, v9, v83
    v_dot2_f32_bf16 v83, v63, v9, v83
    s_add_u32 s43, s42, 51200
    buffer_store_dwordx4 v[60:63], v4, s[24:27], s43 offen
    s_cmp_ge_u32 s3, 2
    s_cbranch_scc1 prep_kernel_e1
    ds_read_b64_tr_b16 v[64:65], v6 offset:12288
    ds_read_b64_tr_b16 v[66:67], v6 offset:12800
    ds_read_b64_tr_b16 v[68:69], v6 offset:12320
    ds_read_b64_tr_b16 v[70:71], v6 offset:12832
    ds_read_b64_tr_b16 v[72:73], v6 offset:12344
    ds_read_b64_tr_b16 v[74:75], v6 offset:12856
    ds_read_b64_tr_b16 v[76:77], v6 offset:12376
    ds_read_b64_tr_b16 v[78:79], v6 offset:12888
    s_waitcnt lgkmcnt(6)
    v_dot2_f32_bf16 v80, v64, v9, v80
    v_dot2_f32_bf16 v80, v65, v9, v80
    v_dot2_f32_bf16 v80, v66, v9, v80
    v_dot2_f32_bf16 v80, v67, v9, v80
    s_add_u32 s43, s42, 12288
    buffer_store_dwordx4 v[64:67], v4, s[24:27], s43 offen
    s_waitcnt lgkmcnt(4)
    v_cndmask_b32 v68, v14, v68, s[44:45]
    v_cndmask_b32 v69, v14, v69, s[44:45]
    v_cndmask_b32 v70, v14, v70, s[44:45]
    v_cndmask_b32 v71, v14, v71, s[44:45]
    v_dot2_f32_bf16 v81, v68, v9, v81
    v_dot2_f32_bf16 v81, v69, v9, v81
    v_dot2_f32_bf16 v81, v70, v9, v81
    v_dot2_f32_bf16 v81, v71, v9, v81
    s_add_u32 s43, s42, 26624
    buffer_store_dwordx4 v[68:71], v4, s[24:27], s43 offen
    s_waitcnt lgkmcnt(2)
    v_dot2_f32_bf16 v82, v72, v9, v82
    v_dot2_f32_bf16 v82, v73, v9, v82
    v_dot2_f32_bf16 v82, v74, v9, v82
    v_dot2_f32_bf16 v82, v75, v9, v82
    s_add_u32 s43, s42, 40960
    buffer_store_dwordx4 v[72:75], v4, s[24:27], s43 offen
    s_waitcnt lgkmcnt(0)
    v_cndmask_b32 v76, v14, v76, s[44:45]
    v_cndmask_b32 v77, v14, v77, s[44:45]
    v_cndmask_b32 v78, v14, v78, s[44:45]
    v_cndmask_b32 v79, v14, v79, s[44:45]
    v_dot2_f32_bf16 v83, v76, v9, v83
    v_dot2_f32_bf16 v83, v77, v9, v83
    v_dot2_f32_bf16 v83, v78, v9, v83
    v_dot2_f32_bf16 v83, v79, v9, v83
    s_add_u32 s43, s42, 55296
    buffer_store_dwordx4 v[76:79], v4, s[24:27], s43 offen
prep_kernel_e1:
    s_nop 4
    v_mov_b32 v84, v80
    s_nop 1
    v_permlane16_swap_b32 v84, v80
    v_add_f32 v80, v84, v80
    v_mov_b32 v84, v80
    s_nop 1
    v_permlane32_swap_b32 v84, v80
    v_add_f32 v80, v84, v80
    v_mov_b32 v84, v81
    s_nop 1
    v_permlane16_swap_b32 v84, v81
    v_add_f32 v81, v84, v81
    v_mov_b32 v84, v81
    s_nop 1
    v_permlane32_swap_b32 v84, v81
    v_add_f32 v81, v84, v81
    v_mov_b32 v84, v82
    s_nop 1
    v_permlane16_swap_b32 v84, v82
    v_add_f32 v82, v84, v82
    v_mov_b32 v84, v82
    s_nop 1
    v_permlane32_swap_b32 v84, v82
    v_add_f32 v82, v84, v82
    v_mov_b32 v84, v83
    s_nop 1
    v_permlane16_swap_b32 v84, v83
    v_add_f32 v83, v84, v83
    v_mov_b32 v84, v83
    s_nop 1
    v_permlane32_swap_b32 v84, v83
    v_add_f32 v83, v84, v83
    s_lshl_b32 s43, s3, 8
    s_add_u32 s43, s43, 0x10000
    v_lshl_add_u32 v84, v3, 2, s43
    ds_write_b32 v84, v80 offset:0
    ds_write_b32 v84, v81 offset:64
    ds_write_b32 v84, v82 offset:128
    ds_write_b32 v84, v83 offset:192
    s_waitcnt lgkmcnt(0)
    s_barrier
    s_cmp_lg_u32 s3, 0
    s_cbranch_scc1 prep_done
    v_lshlrev_b32 v84, 2, v0
    v_add_u32 v85, 0x10000, v84
    ds_read_b32 v80, v85 offset:0
    ds_read_b32 v81, v85 offset:256
    ds_read_b32 v82, v85 offset:512
    ds_read_b32 v83, v85 offset:768
    s_waitcnt lgkmcnt(0)
    v_add_f32 v80, v80, v81
    v_add_f32 v82, v82, v83
    v_add_f32 v80, v80, v82
    s_add_u32 s23, s23, 0x900000
    buffer_store_dword v80, v84, s[24:27], s23 offen
    s_endpgm
prep_gu:
    s_sub_u32 s40, s2, 24
    s_mov_b32 s47, 0
    s_cmp_ge_u32 s40, 28
    s_cselect_b32 s42, s14, s12
    s_cselect_b32 s43, s15, s13
    s_cselect_b32 s41, 28, 0
    s_cselect_b32 s46, 2, 0
    s_mov_b32 s28, s42
    s_mov_b32 s29, s43
    s_mov_b32 s30, 0x188000
    s_mov_b32 s31, 0x20000
    s_sub_u32 s40, s40, s41
    s_lshl_b32 s21, s40, 7
    s_mul_i32 s43, s47, 802816
    s_add_u32 s21, s21, s43
    s_lshl_b32 s42, s40, 3
    s_add_u32 s42, s42, s46
    s_mul_i32 s22, s42, 14336
    s_mul_i32 s43, s47, 7168
    s_add_u32 s22, s22, s43
    s_add_u32 s22, s22, 0x300000
    s_lshl_b32 s23, s42, 6
    s_mul_i32 s43, s47, 32768
    s_add_u32 s23, s23, s43
    v_mul_u32_u24 v5, 3584, v12
    v_lshl_add_u32 v5, v13, 4, v5
    s_mul_i32 s40, s3, 114688
    s_add_u32 s40, s40, s21
    v_lshlrev_b32 v6, 10, v2
    v_add_u32 v6, v6, v10
    v_mov_b32 v80, 0
    v_mov_b32 v81, 0
    v_mov_b32 v82, 0
    v_mov_b32 v83, 0
    s_add_u32 m0, s50, 0
    s_add_u32 s41, s40, 0
    buffer_load_dwordx4 v5, s[28:31], s41 offen lds
    s_add_u32 m0, s50, 1024
    s_add_u32 s41, s40, 28672
    buffer_load_dwordx4 v5, s[28:31], s41 offen lds
    s_add_u32 m0, s50, 2048
    s_add_u32 s41, s40, 57344
    buffer_load_dwordx4 v5, s[28:31], s41 offen lds
    s_add_u32 m0, s50, 3072
    s_add_u32 s41, s40, 86016
    buffer_load_dwordx4 v5, s[28:31], s41 offen lds
    s_add_u32 m0, s50, 4096
    s_add_u32 s41, s40, 458752
    buffer_load_dwordx4 v5, s[28:31], s41 offen lds
    s_add_u32 m0, s50, 5120
    s_add_u32 s41, s40, 487424
    buffer_load_dwordx4 v5, s[28:31], s41 offen lds
    s_add_u32 m0, s50, 6144
    s_add_u32 s41, s40, 516096
    buffer_load_dwordx4 v5, s[28:31], s41 offen lds
    s_add_u32 m0, s50, 7168
    s_add_u32 s41, s40, 544768
    buffer_load_dwordx4 v5, s[28:31], s41 offen lds
    s_add_u32 m0, s50, 8192
    s_add_u32 s41, s40, 917504
    buffer_load_dwordx4 v5, s[28:31], s41 offen lds
    s_add_u32 m0, s50, 9216
    s_add_u32 s41, s40, 946176
    buffer_load_dwordx4 v5, s[28:31], s41 offen lds
    s_add_u32 m0, s50, 10240
    s_add_u32 s41, s40, 974848
    buffer_load_dwordx4 v5, s[28:31], s41 offen lds
    s_add_u32 m0, s50, 11264
    s_add_u32 s41, s40, 1003520
    buffer_load_dwordx4 v5, s[28:31], s41 offen lds
    s_cmp_ge_u32 s3, 2
    s_cbranch_scc1 pg_ld3
    s_add_u32 m0, s50, 12288
    s_add_u32 s41, s40, 1376256
    buffer_load_dwordx4 v5, s[28:31], s41 offen lds
    s_add_u32 m0, s50, 13312
    s_add_u32 s41, s40, 1404928
    buffer_load_dwordx4 v5, s[28:31], s41 offen lds
    s_add_u32 m0, s50, 14336
    s_add_u32 s41, s40, 1433600
    buffer_load_dwordx4 v5, s[28:31], s41 offen lds
    s_add_u32 m0, s50, 15360
    s_add_u32 s41, s40, 1462272
    buffer_load_dwordx4 v5, s[28:31], s41 offen lds
pg_ld3:
    s_waitcnt vmcnt(0)
    s_lshl_b32 s42, s3, 10
    s_add_u32 s42, s42, s22
    ds_read_b64_tr_b16 v[16:17], v6 offset:0
    ds_read_b64_tr_b16 v[18:19], v6 offset:512
    ds_read_b64_tr_b16 v[20:21], v6 offset:32
    ds_read_b64_tr_b16 v[22:23], v6 offset:544
    ds_read_b64_tr_b16 v[24:25], v6 offset:64
    ds_read_b64_tr_b16 v[26:27], v6 offset:576
    ds_read_b64_tr_b16 v[28:29], v6 offset:96
    ds_read_b64_tr_b16 v[30:31], v6 offset:608
    s_waitcnt lgkmcnt(6)
    v_dot2_f32_bf16 v80, v16, v9, v80
    v_dot2_f32_bf16 v80, v17, v9, v80
    v_dot2_f32_bf16 v80, v18, v9, v80
    v_dot2_f32_bf16 v80, v19, v9, v80
    s_add_u32 s43, s42, 0
    buffer_store_dwordx4 v[16:19], v4, s[24:27], s43 offen
    s_waitcnt lgkmcnt(4)
    v_dot2_f32_bf16 v81, v20, v9, v81
    v_dot2_f32_bf16 v81, v21, v9, v81
    v_dot2_f32_bf16 v81, v22, v9, v81
    v_dot2_f32_bf16 v81, v23, v9, v81
    s_add_u32 s43, s42, 14336
    buffer_store_dwordx4 v[20:23], v4, s[24:27], s43 offen
    s_waitcnt lgkmcnt(2)
    v_dot2_f32_bf16 v82, v24, v9, v82
    v_dot2_f32_bf16 v82, v25, v9, v82
    v_dot2_f32_bf16 v82, v26, v9, v82
    v_dot2_f32_bf16 v82, v27, v9, v82
    s_add_u32 s43, s42, 57344
    buffer_store_dwordx4 v[24:27], v4, s[24:27], s43 offen
    s_waitcnt lgkmcnt(0)
    v_dot2_f32_bf16 v83, v28, v9, v83
    v_dot2_f32_bf16 v83, v29, v9, v83
    v_dot2_f32_bf16 v83, v30, v9, v83
    v_dot2_f32_bf16 v83, v31, v9, v83
    s_add_u32 s43, s42, 71680
    buffer_store_dwordx4 v[28:31], v4, s[24:27], s43 offen
    ds_read_b64_tr_b16 v[32:33], v6 offset:4096
    ds_read_b64_tr_b16 v[34:35], v6 offset:4608
    ds_read_b64_tr_b16 v[36:37], v6 offset:4128
    ds_read_b64_tr_b16 v[38:39], v6 offset:4640
    ds_read_b64_tr_b16 v[40:41], v6 offset:4160
    ds_read_b64_tr_b16 v[42:43], v6 offset:4672
    ds_read_b64_tr_b16 v[44:45], v6 offset:4192
    ds_read_b64_tr_b16 v[46:47], v6 offset:4704
    s_waitcnt lgkmcnt(6)
    v_dot2_f32_bf16 v80, v32, v9, v80
    v_dot2_f32_bf16 v80, v33, v9, v80
    v_dot2_f32_bf16 v80, v34, v9, v80
    v_dot2_f32_bf16 v80, v35, v9, v80
    s_add_u32 s43, s42, 4096
    buffer_store_dwordx4 v[32:35], v4, s[24:27], s43 offen
    s_waitcnt lgkmcnt(4)
    v_dot2_f32_bf16 v81, v36, v9, v81
    v_dot2_f32_bf16 v81, v37, v9, v81
    v_dot2_f32_bf16 v81, v38, v9, v81
    v_dot2_f32_bf16 v81, v39, v9, v81
    s_add_u32 s43, s42, 18432
    buffer_store_dwordx4 v[36:39], v4, s[24:27], s43 offen
    s_waitcnt lgkmcnt(2)
    v_dot2_f32_bf16 v82, v40, v9, v82
    v_dot2_f32_bf16 v82, v41, v9, v82
    v_dot2_f32_bf16 v82, v42, v9, v82
    v_dot2_f32_bf16 v82, v43, v9, v82
    s_add_u32 s43, s42, 61440
    buffer_store_dwordx4 v[40:43], v4, s[24:27], s43 offen
    s_waitcnt lgkmcnt(0)
    v_dot2_f32_bf16 v83, v44, v9, v83
    v_dot2_f32_bf16 v83, v45, v9, v83
    v_dot2_f32_bf16 v83, v46, v9, v83
    v_dot2_f32_bf16 v83, v47, v9, v83
    s_add_u32 s43, s42, 75776
    buffer_store_dwordx4 v[44:47], v4, s[24:27], s43 offen
    ds_read_b64_tr_b16 v[48:49], v6 offset:8192
    ds_read_b64_tr_b16 v[50:51], v6 offset:8704
    ds_read_b64_tr_b16 v[52:53], v6 offset:8224
    ds_read_b64_tr_b16 v[54:55], v6 offset:8736
    ds_read_b64_tr_b16 v[56:57], v6 offset:8256
    ds_read_b64_tr_b16 v[58:59], v6 offset:8768
    ds_read_b64_tr_b16 v[60:61], v6 offset:8288
    ds_read_b64_tr_b16 v[62:63], v6 offset:8800
    s_waitcnt lgkmcnt(6)
    v_dot2_f32_bf16 v80, v48, v9, v80
    v_dot2_f32_bf16 v80, v49, v9, v80
    v_dot2_f32_bf16 v80, v50, v9, v80
    v_dot2_f32_bf16 v80, v51, v9, v80
    s_add_u32 s43, s42, 8192
    buffer_store_dwordx4 v[48:51], v4, s[24:27], s43 offen
    s_waitcnt lgkmcnt(4)
    v_dot2_f32_bf16 v81, v52, v9, v81
    v_dot2_f32_bf16 v81, v53, v9, v81
    v_dot2_f32_bf16 v81, v54, v9, v81
    v_dot2_f32_bf16 v81, v55, v9, v81
    s_add_u32 s43, s42, 22528
    buffer_store_dwordx4 v[52:55], v4, s[24:27], s43 offen
    s_waitcnt lgkmcnt(2)
    v_dot2_f32_bf16 v82, v56, v9, v82
    v_dot2_f32_bf16 v82, v57, v9, v82
    v_dot2_f32_bf16 v82, v58, v9, v82
    v_dot2_f32_bf16 v82, v59, v9, v82
    s_add_u32 s43, s42, 65536
    buffer_store_dwordx4 v[56:59], v4, s[24:27], s43 offen
    s_waitcnt lgkmcnt(0)
    v_dot2_f32_bf16 v83, v60, v9, v83
    v_dot2_f32_bf16 v83, v61, v9, v83
    v_dot2_f32_bf16 v83, v62, v9, v83
    v_dot2_f32_bf16 v83, v63, v9, v83
    s_add_u32 s43, s42, 79872
    buffer_store_dwordx4 v[60:63], v4, s[24:27], s43 offen
    s_cmp_ge_u32 s3, 2
    s_cbranch_scc1 prep_kernel_e2
    ds_read_b64_tr_b16 v[64:65], v6 offset:12288
    ds_read_b64_tr_b16 v[66:67], v6 offset:12800
    ds_read_b64_tr_b16 v[68:69], v6 offset:12320
    ds_read_b64_tr_b16 v[70:71], v6 offset:12832
    ds_read_b64_tr_b16 v[72:73], v6 offset:12352
    ds_read_b64_tr_b16 v[74:75], v6 offset:12864
    ds_read_b64_tr_b16 v[76:77], v6 offset:12384
    ds_read_b64_tr_b16 v[78:79], v6 offset:12896
    s_waitcnt lgkmcnt(6)
    v_dot2_f32_bf16 v80, v64, v9, v80
    v_dot2_f32_bf16 v80, v65, v9, v80
    v_dot2_f32_bf16 v80, v66, v9, v80
    v_dot2_f32_bf16 v80, v67, v9, v80
    s_add_u32 s43, s42, 12288
    buffer_store_dwordx4 v[64:67], v4, s[24:27], s43 offen
    s_waitcnt lgkmcnt(4)
    v_dot2_f32_bf16 v81, v68, v9, v81
    v_dot2_f32_bf16 v81, v69, v9, v81
    v_dot2_f32_bf16 v81, v70, v9, v81
    v_dot2_f32_bf16 v81, v71, v9, v81
    s_add_u32 s43, s42, 26624
    buffer_store_dwordx4 v[68:71], v4, s[24:27], s43 offen
    s_waitcnt lgkmcnt(2)
    v_dot2_f32_bf16 v82, v72, v9, v82
    v_dot2_f32_bf16 v82, v73, v9, v82
    v_dot2_f32_bf16 v82, v74, v9, v82
    v_dot2_f32_bf16 v82, v75, v9, v82
    s_add_u32 s43, s42, 69632
    buffer_store_dwordx4 v[72:75], v4, s[24:27], s43 offen
    s_waitcnt lgkmcnt(0)
    v_dot2_f32_bf16 v83, v76, v9, v83
    v_dot2_f32_bf16 v83, v77, v9, v83
    v_dot2_f32_bf16 v83, v78, v9, v83
    v_dot2_f32_bf16 v83, v79, v9, v83
    s_add_u32 s43, s42, 83968
    buffer_store_dwordx4 v[76:79], v4, s[24:27], s43 offen
prep_kernel_e2:
    s_nop 4
    v_mov_b32 v84, v80
    s_nop 1
    v_permlane16_swap_b32 v84, v80
    v_add_f32 v80, v84, v80
    v_mov_b32 v84, v80
    s_nop 1
    v_permlane32_swap_b32 v84, v80
    v_add_f32 v80, v84, v80
    v_mov_b32 v84, v81
    s_nop 1
    v_permlane16_swap_b32 v84, v81
    v_add_f32 v81, v84, v81
    v_mov_b32 v84, v81
    s_nop 1
    v_permlane32_swap_b32 v84, v81
    v_add_f32 v81, v84, v81
    v_mov_b32 v84, v82
    s_nop 1
    v_permlane16_swap_b32 v84, v82
    v_add_f32 v82, v84, v82
    v_mov_b32 v84, v82
    s_nop 1
    v_permlane32_swap_b32 v84, v82
    v_add_f32 v82, v84, v82
    v_mov_b32 v84, v83
    s_nop 1
    v_permlane16_swap_b32 v84, v83
    v_add_f32 v83, v84, v83
    v_mov_b32 v84, v83
    s_nop 1
    v_permlane32_swap_b32 v84, v83
    v_add_f32 v83, v84, v83
    s_lshl_b32 s43, s3, 8
    s_add_u32 s43, s43, 0x10000
    v_lshl_add_u32 v84, v3, 2, s43
    ds_write_b32 v84, v80 offset:0
    ds_write_b32 v84, v81 offset:64
    ds_write_b32 v84, v82 offset:128
    ds_write_b32 v84, v83 offset:192
    s_waitcnt lgkmcnt(0)
    s_barrier
    s_cmp_lg_u32 s3, 0
    s_cbranch_scc1 prep_done
    v_lshlrev_b32 v84, 2, v0
    v_add_u32 v85, 0x10000, v84
    ds_read_b32 v80, v85 offset:0
    ds_read_b32 v81, v85 offset:256
    ds_read_b32 v82, v85 offset:512
    ds_read_b32 v83, v85 offset:768
    v_lshrrev_b32 v86, 5, v0
    v_lshl_add_u32 v84, v86, 7, v84
    s_waitcnt lgkmcnt(0)
    v_add_f32 v80, v80, v81
    v_add_f32 v82, v82, v83
    v_add_f32 v80, v80, v82
    s_add_u32 s23, s23, 0x904000
    buffer_store_dword v80, v84, s[24:27], s23 offen
    s_waitcnt vmcnt(0)
    s_endpgm
prep_wd:
    s_mov_b32 s28, s16
    s_mov_b32 s29, s17
    s_mov_b32 s30, 0x188000
    s_mov_b32 s31, 0x20000
    s_sub_u32 s40, s2, 80
    s_mul_i32 s41, s40, 9363
    s_lshr_b32 s41, s41, 16
    s_mul_i32 s42, s41, 7
    s_sub_u32 s42, s40, s42
    s_mul_i32 s21, s41, 401408
    s_lshl_b32 s43, s42, 7
    s_add_u32 s21, s21, s43
    s_mul_i32 s22, s42, 229376
    s_mul_i32 s43, s41, 14336
    s_add_u32 s22, s22, s43
    s_add_u32 s22, s22, 0x700000
    v_mul_u32_u24 v5, 896, v12
    v_lshl_add_u32 v5, v13, 4, v5
    s_mul_i32 s40, s3, 28672
    s_add_u32 s40, s40, s21
    v_lshlrev_b32 v6, 9, v2
    v_add_u32 v6, v6, v10
    v_mov_b32 v80, 0
    v_mov_b32 v81, 0
    v_mov_b32 v82, 0
    v_mov_b32 v83, 0
    s_add_u32 m0, s50, 0
    s_add_u32 s41, s40, 0
    buffer_load_dwordx4 v5, s[28:31], s41 offen lds
    s_add_u32 m0, s50, 1024
    s_add_u32 s41, s40, 7168
    buffer_load_dwordx4 v5, s[28:31], s41 offen lds
    s_add_u32 m0, s50, 2048
    s_add_u32 s41, s40, 14336
    buffer_load_dwordx4 v5, s[28:31], s41 offen lds
    s_add_u32 m0, s50, 3072
    s_add_u32 s41, s40, 21504
    buffer_load_dwordx4 v5, s[28:31], s41 offen lds
    s_add_u32 m0, s50, 4096
    s_add_u32 s41, s40, 114688
    buffer_load_dwordx4 v5, s[28:31], s41 offen lds
    s_add_u32 m0, s50, 5120
    s_add_u32 s41, s40, 121856
    buffer_load_dwordx4 v5, s[28:31], s41 offen lds
    s_add_u32 m0, s50, 6144
    s_add_u32 s41, s40, 129024
    buffer_load_dwordx4 v5, s[28:31], s41 offen lds
    s_add_u32 m0, s50, 7168
    s_add_u32 s41, s40, 136192
    buffer_load_dwordx4 v5, s[28:31], s41 offen lds
    s_add_u32 m0, s50, 8192
    s_add_u32 s41, s40, 229376
    buffer_load_dwordx4 v5, s[28:31], s41 offen lds
    s_add_u32 m0, s50, 9216
    s_add_u32 s41, s40, 236544
    buffer_load_dwordx4 v5, s[28:31], s41 offen lds
    s_add_u32 m0, s50, 10240
    s_add_u32 s41, s40, 243712
    buffer_load_dwordx4 v5, s[28:31], s41 offen lds
    s_add_u32 m0, s50, 11264
    s_add_u32 s41, s40, 250880
    buffer_load_dwordx4 v5, s[28:31], s41 offen lds
    s_cmp_ge_u32 s3, 2
    s_cbranch_scc1 pd_ld3
    s_add_u32 m0, s50, 12288
    s_add_u32 s41, s40, 344064
    buffer_load_dwordx4 v5, s[28:31], s41 offen lds
    s_add_u32 m0, s50, 13312
    s_add_u32 s41, s40, 351232
    buffer_load_dwordx4 v5, s[28:31], s41 offen lds
    s_add_u32 m0, s50, 14336
    s_add_u32 s41, s40, 358400
    buffer_load_dwordx4 v5, s[28:31], s41 offen lds
    s_add_u32 m0, s50, 15360
    s_add_u32 s41, s40, 365568
    buffer_load_dwordx4 v5, s[28:31], s41 offen lds
pd_ld3:
    s_waitcnt vmcnt(0)
    s_lshl_b32 s42, s3, 10
    s_add_u32 s42, s42, s22
    ds_read_b64_tr_b16 v[16:17], v6 offset:0
    ds_read_b64_tr_b16 v[18:19], v6 offset:2048
    ds_read_b64_tr_b16 v[20:21], v6 offset:32
    ds_read_b64_tr_b16 v[22:23], v6 offset:2080
    ds_read_b64_tr_b16 v[24:25], v6 offset:64
    ds_read_b64_tr_b16 v[26:27], v6 offset:2112
    ds_read_b64_tr_b16 v[28:29], v6 offset:96
    ds_read_b64_tr_b16 v[30:31], v6 offset:2144
    s_waitcnt lgkmcnt(6)
    s_add_u32 s43, s42, 0
    buffer_store_dwordx4 v[16:19], v4, s[24:27], s43 offen
    s_waitcnt lgkmcnt(4)
    s_add_u32 s43, s42, 57344
    buffer_store_dwordx4 v[20:23], v4, s[24:27], s43 offen
    s_waitcnt lgkmcnt(2)
    s_add_u32 s43, s42, 114688
    buffer_store_dwordx4 v[24:27], v4, s[24:27], s43 offen
    s_waitcnt lgkmcnt(0)
    s_add_u32 s43, s42, 172032
    buffer_store_dwordx4 v[28:31], v4, s[24:27], s43 offen
    ds_read_b64_tr_b16 v[32:33], v6 offset:4096
    ds_read_b64_tr_b16 v[34:35], v6 offset:6144
    ds_read_b64_tr_b16 v[36:37], v6 offset:4128
    ds_read_b64_tr_b16 v[38:39], v6 offset:6176
    ds_read_b64_tr_b16 v[40:41], v6 offset:4160
    ds_read_b64_tr_b16 v[42:43], v6 offset:6208
    ds_read_b64_tr_b16 v[44:45], v6 offset:4192
    ds_read_b64_tr_b16 v[46:47], v6 offset:6240
    s_waitcnt lgkmcnt(6)
    s_add_u32 s43, s42, 4096
    buffer_store_dwordx4 v[32:35], v4, s[24:27], s43 offen
    s_waitcnt lgkmcnt(4)
    s_add_u32 s43, s42, 61440
    buffer_store_dwordx4 v[36:39], v4, s[24:27], s43 offen
    s_waitcnt lgkmcnt(2)
    s_add_u32 s43, s42, 118784
    buffer_store_dwordx4 v[40:43], v4, s[24:27], s43 offen
    s_waitcnt lgkmcnt(0)
    s_add_u32 s43, s42, 176128
    buffer_store_dwordx4 v[44:47], v4, s[24:27], s43 offen
    ds_read_b64_tr_b16 v[48:49], v6 offset:8192
    ds_read_b64_tr_b16 v[50:51], v6 offset:10240
    ds_read_b64_tr_b16 v[52:53], v6 offset:8224
    ds_read_b64_tr_b16 v[54:55], v6 offset:10272
    ds_read_b64_tr_b16 v[56:57], v6 offset:8256
    ds_read_b64_tr_b16 v[58:59], v6 offset:10304
    ds_read_b64_tr_b16 v[60:61], v6 offset:8288
    ds_read_b64_tr_b16 v[62:63], v6 offset:10336
    s_waitcnt lgkmcnt(6)
    s_add_u32 s43, s42, 8192
    buffer_store_dwordx4 v[48:51], v4, s[24:27], s43 offen
    s_waitcnt lgkmcnt(4)
    s_add_u32 s43, s42, 65536
    buffer_store_dwordx4 v[52:55], v4, s[24:27], s43 offen
    s_waitcnt lgkmcnt(2)
    s_add_u32 s43, s42, 122880
    buffer_store_dwordx4 v[56:59], v4, s[24:27], s43 offen
    s_waitcnt lgkmcnt(0)
    s_add_u32 s43, s42, 180224
    buffer_store_dwordx4 v[60:63], v4, s[24:27], s43 offen
    s_cmp_ge_u32 s3, 2
    s_cbranch_scc1 prep_kernel_e3
    ds_read_b64_tr_b16 v[64:65], v6 offset:12288
    ds_read_b64_tr_b16 v[66:67], v6 offset:14336
    ds_read_b64_tr_b16 v[68:69], v6 offset:12320
    ds_read_b64_tr_b16 v[70:71], v6 offset:14368
    ds_read_b64_tr_b16 v[72:73], v6 offset:12352
    ds_read_b64_tr_b16 v[74:75], v6 offset:14400
    ds_read_b64_tr_b16 v[76:77], v6 offset:12384
    ds_read_b64_tr_b16 v[78:79], v6 offset:14432
    s_waitcnt lgkmcnt(6)
    s_add_u32 s43, s42, 12288
    buffer_store_dwordx4 v[64:67], v4, s[24:27], s43 offen
    s_waitcnt lgkmcnt(4)
    s_add_u32 s43, s42, 69632
    buffer_store_dwordx4 v[68:71], v4, s[24:27], s43 offen
    s_waitcnt lgkmcnt(2)
    s_add_u32 s43, s42, 126976
    buffer_store_dwordx4 v[72:75], v4, s[24:27], s43 offen
    s_waitcnt lgkmcnt(0)
    s_add_u32 s43, s42, 184320
    buffer_store_dwordx4 v[76:79], v4, s[24:27], s43 offen
prep_kernel_e3:
    s_endpgm
prep_wo:
    s_mov_b32 s28, s6
    s_mov_b32 s29, s7
    s_mov_b32 s30, 0x62000
    s_mov_b32 s31, 0x20000
    s_sub_u32 s42, s2, 108
    s_mov_b32 s47, 0
    s_lshl_b32 s21, s42, 7
    s_mul_i32 s43, s47, 200704
    s_add_u32 s21, s21, s43
    s_mul_i32 s22, s42, 65536
    s_lshl_b32 s43, s47, 13
    s_add_u32 s22, s22, s43
    s_add_u32 s22, s22, 0x200000
    v_mul_u32_u24 v5, 896, v12
    v_lshl_add_u32 v5, v13, 4, v5
    s_mul_i32 s40, s3, 25088
    s_add_u32 s40, s40, s21
    v_lshlrev_b32 v6, 9, v2
    v_add_u32 v6, v6, v10
    v_mov_b32 v80, 0
    v_mov_b32 v81, 0
    v_mov_b32 v82, 0
    v_mov_b32 v83, 0
    v_cmp_gt_u32 s[44:45], 3, v2
    s_add_u32 m0, s50, 0
    s_add_u32 s41, s40, 0
    buffer_load_dwordx4 v5, s[28:31], s41 offen lds
    s_add_u32 m0, s50, 1024
    s_add_u32 s41, s40, 7168
    buffer_load_dwordx4 v5, s[28:31], s41 offen lds
    s_add_u32 m0, s50, 2048
    s_add_u32 s41, s40, 14336
    buffer_load_dwordx4 v5, s[28:31], s41 offen lds
    s_add_u32 m0, s50, 3072
    s_add_u32 s41, s40, 21504
    buffer_load_dwordx4 v5, s[28:31], s41 offen lds
    s_add_u32 m0, s50, 4096
    s_add_u32 s41, s40, 100352
    buffer_load_dwordx4 v5, s[28:31], s41 offen lds
    s_add_u32 m0, s50, 5120
    s_add_u32 s41, s40, 107520
    buffer_load_dwordx4 v5, s[28:31], s41 offen lds
    s_add_u32 m0, s50, 6144
    s_add_u32 s41, s40, 114688
    buffer_load_dwordx4 v5, s[28:31], s41 offen lds
    s_add_u32 m0, s50, 7168
    s_add_u32 s41, s40, 121856
    buffer_load_dwordx4 v5, s[28:31], s41 offen lds
    s_add_u32 m0, s50, 8192
    s_add_u32 s41, s40, 200704
    buffer_load_dwordx4 v5, s[28:31], s41 offen lds
    s_add_u32 m0, s50, 9216
    s_add_u32 s41, s40, 207872
    buffer_load_dwordx4 v5, s[28:31], s41 offen lds
    s_add_u32 m0, s50, 10240
    s_add_u32 s41, s40, 215040
    buffer_load_dwordx4 v5, s[28:31], s41 offen lds
    s_add_u32 m0, s50, 11264
    s_add_u32 s41, s40, 222208
    buffer_load_dwordx4 v5, s[28:31], s41 offen lds
    s_add_u32 m0, s50, 12288
    s_add_u32 s41, s40, 301056
    buffer_load_dwordx4 v5, s[28:31], s41 offen lds
    s_add_u32 m0, s50, 13312
    s_add_u32 s41, s40, 308224
    buffer_load_dwordx4 v5, s[28:31], s41 offen lds
    s_add_u32 m0, s50, 14336
    s_add_u32 s41, s40, 315392
    buffer_load_dwordx4 v5, s[28:31], s41 offen lds
    s_add_u32 m0, s50, 15360
    s_add_u32 s41, s40, 322560
    buffer_load_dwordx4 v5, s[28:31], s41 offen lds
    s_waitcnt vmcnt(0)
    s_lshl_b32 s42, s3, 10
    s_add_u32 s42, s42, s22
    ds_read_b64_tr_b16 v[16:17], v6 offset:0
    ds_read_b64_tr_b16 v[18:19], v6 offset:2048
    ds_read_b64_tr_b16 v[20:21], v6 offset:32
    ds_read_b64_tr_b16 v[22:23], v6 offset:2080
    ds_read_b64_tr_b16 v[24:25], v6 offset:64
    ds_read_b64_tr_b16 v[26:27], v6 offset:2112
    ds_read_b64_tr_b16 v[28:29], v6 offset:96
    ds_read_b64_tr_b16 v[30:31], v6 offset:2144
    s_waitcnt lgkmcnt(6)
    v_cndmask_b32 v18, 0, v18, s[44:45]
    v_cndmask_b32 v19, 0, v19, s[44:45]
    s_add_u32 s43, s42, 0
    buffer_store_dwordx4 v[16:19], v4, s[24:27], s43 offen
    s_waitcnt lgkmcnt(4)
    v_cndmask_b32 v22, 0, v22, s[44:45]
    v_cndmask_b32 v23, 0, v23, s[44:45]
    s_add_u32 s43, s42, 16384
    buffer_store_dwordx4 v[20:23], v4, s[24:27], s43 offen
    s_waitcnt lgkmcnt(2)
    v_cndmask_b32 v26, 0, v26, s[44:45]
    v_cndmask_b32 v27, 0, v27, s[44:45]
    s_add_u32 s43, s42, 32768
    buffer_store_dwordx4 v[24:27], v4, s[24:27], s43 offen
    s_waitcnt lgkmcnt(0)
    v_cndmask_b32 v30, 0, v30, s[44:45]
    v_cndmask_b32 v31, 0, v31, s[44:45]
    s_add_u32 s43, s42, 49152
    buffer_store_dwordx4 v[28:31], v4, s[24:27], s43 offen
    ds_read_b64_tr_b16 v[32:33], v6 offset:4096
    ds_read_b64_tr_b16 v[34:35], v6 offset:6144
    ds_read_b64_tr_b16 v[36:37], v6 offset:4128
    ds_read_b64_tr_b16 v[38:39], v6 offset:6176
    ds_read_b64_tr_b16 v[40:41], v6 offset:4160
    ds_read_b64_tr_b16 v[42:43], v6 offset:6208
    ds_read_b64_tr_b16 v[44:45], v6 offset:4192
    ds_read_b64_tr_b16 v[46:47], v6 offset:6240
    s_waitcnt lgkmcnt(6)
    v_cndmask_b32 v34, 0, v34, s[44:45]
    v_cndmask_b32 v35, 0, v35, s[44:45]
    s_add_u32 s43, s42, 4096
    buffer_store_dwordx4 v[32:35], v4, s[24:27], s43 offen
    s_waitcnt lgkmcnt(4)
    v_cndmask_b32 v38, 0, v38, s[44:45]
    v_cndmask_b32 v39, 0, v39, s[44:45]
    s_add_u32 s43, s42, 20480
    buffer_store_dwordx4 v[36:39], v4, s[24:27], s43 offen
    s_waitcnt lgkmcnt(2)
    v_cndmask_b32 v42, 0, v42, s[44:45]
    v_cndmask_b32 v43, 0, v43, s[44:45]
    s_add_u32 s43, s42, 36864
    buffer_store_dwordx4 v[40:43], v4, s[24:27], s43 offen
    s_waitcnt lgkmcnt(0)
    v_cndmask_b32 v46, 0, v46, s[44:45]
    v_cndmask_b32 v47, 0, v47, s[44:45]
    s_add_u32 s43, s42, 53248
    buffer_store_dwordx4 v[44:47], v4, s[24:27], s43 offen
    ds_read_b64_tr_b16 v[48:49], v6 offset:8192
    ds_read_b64_tr_b16 v[50:51], v6 offset:10240
    ds_read_b64_tr_b16 v[52:53], v6 offset:8224
    ds_read_b64_tr_b16 v[54:55], v6 offset:10272
    ds_read_b64_tr_b16 v[56:57], v6 offset:8256
    ds_read_b64_tr_b16 v[58:59], v6 offset:10304
    ds_read_b64_tr_b16 v[60:61], v6 offset:8288
    ds_read_b64_tr_b16 v[62:63], v6 offset:10336
    s_waitcnt lgkmcnt(6)
    v_cndmask_b32 v50, 0, v50, s[44:45]
    v_cndmask_b32 v51, 0, v51, s[44:45]
    s_add_u32 s43, s42, 8192
    buffer_store_dwordx4 v[48:51], v4, s[24:27], s43 offen
    s_waitcnt lgkmcnt(4)
    v_cndmask_b32 v54, 0, v54, s[44:45]
    v_cndmask_b32 v55, 0, v55, s[44:45]
    s_add_u32 s43, s42, 24576
    buffer_store_dwordx4 v[52:55], v4, s[24:27], s43 offen
    s_waitcnt lgkmcnt(2)
    v_cndmask_b32 v58, 0, v58, s[44:45]
    v_cndmask_b32 v59, 0, v59, s[44:45]
    s_add_u32 s43, s42, 40960
    buffer_store_dwordx4 v[56:59], v4, s[24:27], s43 offen
    s_waitcnt lgkmcnt(0)
    v_cndmask_b32 v62, 0, v62, s[44:45]
    v_cndmask_b32 v63, 0, v63, s[44:45]
    s_add_u32 s43, s42, 57344
    buffer_store_dwordx4 v[60:63], v4, s[24:27], s43 offen
    ds_read_b64_tr_b16 v[64:65], v6 offset:12288
    ds_read_b64_tr_b16 v[66:67], v6 offset:14336
    ds_read_b64_tr_b16 v[68:69], v6 offset:12320
    ds_read_b64_tr_b16 v[70:71], v6 offset:14368
    ds_read_b64_tr_b16 v[72:73], v6 offset:12352
    ds_read_b64_tr_b16 v[74:75], v6 offset:14400
    ds_read_b64_tr_b16 v[76:77], v6 offset:12384
    ds_read_b64_tr_b16 v[78:79], v6 offset:14432
    s_waitcnt lgkmcnt(6)
    v_cndmask_b32 v66, 0, v66, s[44:45]
    v_cndmask_b32 v67, 0, v67, s[44:45]
    s_add_u32 s43, s42, 12288
    buffer_store_dwordx4 v[64:67], v4, s[24:27], s43 offen
    s_waitcnt lgkmcnt(4)
    v_cndmask_b32 v70, 0, v70, s[44:45]
    v_cndmask_b32 v71, 0, v71, s[44:45]
    s_add_u32 s43, s42, 28672
    buffer_store_dwordx4 v[68:71], v4, s[24:27], s43 offen
    s_waitcnt lgkmcnt(2)
    v_cndmask_b32 v74, 0, v74, s[44:45]
    v_cndmask_b32 v75, 0, v75, s[44:45]
    s_add_u32 s43, s42, 45056
    buffer_store_dwordx4 v[72:75], v4, s[24:27], s43 offen
    s_waitcnt lgkmcnt(0)
    v_cndmask_b32 v78, 0, v78, s[44:45]
    v_cndmask_b32 v79, 0, v79, s[44:45]
    s_add_u32 s43, s42, 61440
    buffer_store_dwordx4 v[76:79], v4, s[24:27], s43 offen
prep_kernel_e4:
    s_endpgm
prep_done:
    s_endpgm
.globl qa_kernel
.p2align 8
.type qa_kernel,@function
qa_kernel:
    s_cmp_ge_u32 s2, 256
    s_cbranch_scc1 qa_kernel_done
    s_load_dwordx2 s[4:5], s[0:1], 72
    v_lshrrev_b32 v1, 6, v0
    v_and_b32 v0, 63, v0
    s_nop 0
    v_readfirstlane_b32 s3, v1
    v_lshrrev_b32 v2, 4, v0
    v_and_b32 v3, 15, v0
    v_lshlrev_b32 v5, 4, v0
    s_and_b32 s20, s2, 15
    s_lshr_b32 s21, s2, 4
    s_lshl_b32 s22, s21, 3
    s_add_u32 s23, s22, s3
    s_mul_i32 s24, s23, 14336
    v_add_u32 v6, s24, v5
    s_lshr_b32 s27, s20, 1
    s_mul_i32 s27, s27, 12
    s_and_b32 s28, s20, 1
    s_lshl_b32 s28, s28, 1
    s_add_u32 s27, s27, s28
    s_lshl_b32 s28, s27, 6
    s_add_u32 s28, s28, 0x900000
    s_mul_i32 s27, s27, 14336
    v_lshlrev_b32 v12, 4, v2
    v_lshlrev_b32 v13, 2, v3
    s_lshl_b32 s25, s20, 17
    s_waitcnt lgkmcnt(0)
    s_add_u32 s8, s4, 0x1e00000
    s_addc_u32 s9, s5, 0
    s_mov_b32 s10, 0x1c0000
    s_mov_b32 s11, 0x20000
    s_mov_b32 s12, s4
    s_mov_b32 s13, s5
    s_mov_b32 s14, 0x1000000
    s_mov_b32 s15, 0x20000
    s_mov_b32 s16, s4
    s_mov_b32 s17, s5
    s_mov_b32 s18, 0x150000
    s_mov_b32 s19, 0x20000
    s_add_u32 s48, s4, 0x1000000
    s_addc_u32 s49, s5, 0
    s_mov_b32 s50, 0x200000
    s_mov_b32 s51, 0x20000
    s_add_u32 s26, s25, 0xc00000
    s_add_u32 s80, s4, s26
    s_addc_u32 s81, s5, 0
    s_mov_b32 s82, 0x20000
    s_mov_b32 s83, 0x20000
    s_add_u32 s26, s25, 0xe00000
    s_add_u32 s84, s4, s26
    s_addc_u32 s85, s5, 0
    s_mov_b32 s86, 0x10000
    s_mov_b32 s87, 0x20000
    s_add_u32 s26, s25, 0xe10000
    s_add_u32 s88, s4, s26
    s_addc_u32 s89, s5, 0
    s_mov_b32 s90, 0x10000
    s_mov_b32 s91, 0x20000
    s_add_u32 s92, s4, 0x9e0000
    s_addc_u32 s93, s5, 0
    s_mov_b32 s94, 0x4000
    s_mov_b32 s95, 0x20000
    s_or_b32 s26, s2, s3
    s_cmp_lg_u32 s26, 0
    s_cbranch_scc1 qa_kernel_z1
    v_lshlrev_b32 v16, 8, v0
    v_mov_b32 v17, 0
    s_mov_b32 s26, 0x9f0000
    buffer_store_dword v17, v16, s[12:15], s26 offen
qa_kernel_z1:
    buffer_load_dwordx4 v[148:151], v12, s[12:15], s28 offen offset:0
    buffer_load_dwordx4 v[152:155], v12, s[12:15], s28 offen offset:64
    buffer_load_dwordx4 v[156:159], v12, s[12:15], s28 offen offset:256
    buffer_load_dwordx4 v[160:163], v12, s[12:15], s28 offen offset:320
    buffer_load_dword v164, v13, s[12:15], s28 offen offset:512
    buffer_load_dword v165, v13, s[12:15], s28 offen offset:576
    s_add_u32 s32, s3, 0
    s_mul_i32 s33, s32, 43
    s_lshr_b32 s33, s33, 8
    s_mul_i32 s34, s33, 6
    s_sub_u32 s34, s32, s34
    s_lshr_b32 s35, s34, 1
    s_lshl_b32 s35, s35, 2
    s_and_b32 s34, s34, 1
    s_add_u32 s34, s34, s35
    s_mul_i32 s34, s34, 14
    s_add_u32 s34, s34, s33
    s_lshl_b32 s34, s34, 10
    s_add_u32 s34, s34, s27
    s_cmp_ge_u32 s32, 84
    s_cselect_b32 s34, 0x7ff00000, s34
    s_lshl_b32 m0, s32, 10
    s_nop 0
    buffer_load_dwordx4 v5, s[16:19], s34 offen lds
    s_mov_b32 s36, 0
    buffer_load_dwordx4 v[16:19], v6, s[8:11], s36 offen offset:0
    s_add_u32 s32, s3, 8
    s_mul_i32 s33, s32, 43
    s_lshr_b32 s33, s33, 8
    s_mul_i32 s34, s33, 6
    s_sub_u32 s34, s32, s34
    s_lshr_b32 s35, s34, 1
    s_lshl_b32 s35, s35, 2
    s_and_b32 s34, s34, 1
    s_add_u32 s34, s34, s35
    s_mul_i32 s34, s34, 14
    s_add_u32 s34, s34, s33
    s_lshl_b32 s34, s34, 10
    s_add_u32 s34, s34, s27
    s_cmp_ge_u32 s32, 84
    s_cselect_b32 s34, 0x7ff00000, s34
    s_lshl_b32 m0, s32, 10
    s_nop 0
    buffer_load_dwordx4 v5, s[16:19], s34 offen lds
    s_mov_b32 s36, 0
    buffer_load_dwordx4 v[20:23], v6, s[8:11], s36 offen offset:1024
    s_add_u32 s32, s3, 16
    s_mul_i32 s33, s32, 43
    s_lshr_b32 s33, s33, 8
    s_mul_i32 s34, s33, 6
    s_sub_u32 s34, s32, s34
    s_lshr_b32 s35, s34, 1
    s_lshl_b32 s35, s35, 2
    s_and_b32 s34, s34, 1
    s_add_u32 s34, s34, s35
    s_mul_i32 s34, s34, 14
    s_add_u32 s34, s34, s33
    s_lshl_b32 s34, s34, 10
    s_add_u32 s34, s34, s27
    s_cmp_ge_u32 s32, 84
    s_cselect_b32 s34, 0x7ff00000, s34
    s_lshl_b32 m0, s32, 10
    s_nop 0
    buffer_load_dwordx4 v5, s[16:19], s34 offen lds
    s_mov_b32 s36, 0
    buffer_load_dwordx4 v[24:27], v6, s[8:11], s36 offen offset:2048
    v_add_u32 v14, 0xc000, v5
    s_waitcnt vmcnt(5)
    s_barrier
    ds_read_b128 v[80:83], v5 offset:2048
    ds_read_b128 v[84:87], v5 offset:3072
    ds_read_b128 v[88:91], v5 offset:4096
    ds_read_b128 v[92:95], v5 offset:5120
    s_waitcnt vmcnt(3)
    s_barrier
    s_waitcnt lgkmcnt(0)
    ds_read_b128 v[104:107], v5 offset:8192
    ds_read_b128 v[108:111], v5 offset:9216
    ds_read_b128 v[112:115], v5 offset:10240
    ds_read_b128 v[116:119], v5 offset:11264
    v_mfma_f32_16x16x32_bf16 v[128:131], v[80:83], v[16:19], 0
    v_mfma_f32_16x16x32_bf16 v[132:135], v[84:87], v[16:19], 0
    s_mov_b32 s36, 0
    buffer_load_dwordx4 v[28:31], v6, s[8:11], s36 offen offset:3072
    s_add_u32 s32, s3, 24
    s_mul_i32 s33, s32, 43
    s_lshr_b32 s33, s33, 8
    s_mul_i32 s34, s33, 6
    s_sub_u32 s34, s32, s34
    s_lshr_b32 s35, s34, 1
    s_lshl_b32 s35, s35, 2
    s_and_b32 s34, s34, 1
    s_add_u32 s34, s34, s35
    s_mul_i32 s34, s34, 14
    s_add_u32 s34, s34, s33
    s_lshl_b32 s34, s34, 10
    s_add_u32 s34, s34, s27
    s_cmp_ge_u32 s32, 84
    s_cselect_b32 s34, 0x7ff00000, s34
    s_lshl_b32 m0, s32, 10
    s_nop 0
    buffer_load_dwordx4 v5, s[16:19], s34 offen lds
    s_mov_b32 s36, 4096
    buffer_load_dwordx4 v[32:35], v6, s[8:11], s36 offen offset:0
    v_mfma_f32_16x16x32_bf16 v[136:139], v[16:19], v[88:91], 0
    v_mfma_f32_16x16x32_bf16 v[140:143], v[16:19], v[92:95], 0
    v_mfma_f32_16x16x32_bf16 v[144:147], v[16:19], v[16:19], 0
    s_waitcnt vmcnt(4)
    s_barrier
    s_waitcnt lgkmcnt(0)
    ds_read_b128 v[80:83], v5 offset:14336
    ds_read_b128 v[84:87], v5 offset:15360
    ds_read_b128 v[88:91], v5 offset:16384
    ds_read_b128 v[92:95], v5 offset:17408
    v_mfma_f32_16x16x32_bf16 v[128:131], v[104:107], v[20:23], v[128:131]
    v_mfma_f32_16x16x32_bf16 v[132:135], v[108:111], v[20:23], v[132:135]
    s_add_u32 s32, s3, 32
    s_mul_i32 s33, s32, 43
    s_lshr_b32 s33, s33, 8
    s_mul_i32 s34, s33, 6
    s_sub_u32 s34, s32, s34
    s_lshr_b32 s35, s34, 1
    s_lshl_b32 s35, s35, 2
    s_and_b32 s34, s34, 1
    s_add_u32 s34, s34, s35
    s_mul_i32 s34, s34, 14
    s_add_u32 s34, s34, s33
    s_lshl_b32 s34, s34, 10
    s_add_u32 s34, s34, s27
    s_cmp_ge_u32 s32, 84
    s_cselect_b32 s34, 0x7ff00000, s34
    s_lshl_b32 m0, s32, 10
    s_nop 0
    buffer_load_dwordx4 v5, s[16:19], s34 offen lds
    s_mov_b32 s36, 4096
    buffer_load_dwordx4 v[36:39], v6, s[8:11], s36 offen offset:1024
    s_add_u32 s32, s3, 40
    s_mul_i32 s33, s32, 43
    s_lshr_b32 s33, s33, 8
    s_mul_i32 s34, s33, 6
    s_sub_u32 s34, s32, s34
    s_lshr_b32 s35, s34, 1
    s_lshl_b32 s35, s35, 2
    s_and_b32 s34, s34, 1
    s_add_u32 s34, s34, s35
    s_mul_i32 s34, s34, 14
    s_add_u32 s34, s34, s33
    s_lshl_b32 s34, s34, 10
    s_add_u32 s34, s34, s27
    s_cmp_ge_u32 s32, 84
    s_cselect_b32 s34, 0x7ff00000, s34
    s_lshl_b32 m0, s32, 10
    s_nop 0
    buffer_load_dwordx4 v5, s[16:19], s34 offen lds
    s_mov_b32 s36, 4096
    buffer_load_dwordx4 v[40:43], v6, s[8:11], s36 offen offset:2048
    v_mfma_f32_16x16x32_bf16 v[136:139], v[20:23], v[112:115], v[136:139]
    v_mfma_f32_16x16x32_bf16 v[140:143], v[20:23], v[116:119], v[140:143]
    v_mfma_f32_16x16x32_bf16 v[144:147], v[20:23], v[20:23], v[144:147]
    s_waitcnt vmcnt(7)
    s_waitcnt lgkmcnt(0)
    ds_read_b128 v[104:107], v5 offset:20480
    ds_read_b128 v[108:111], v5 offset:21504
    ds_read_b128 v[112:115], v5 offset:22528
    ds_read_b128 v[116:119], v5 offset:23552
    v_mfma_f32_16x16x32_bf16 v[128:131], v[80:83], v[24:27], v[128:131]
    v_mfma_f32_16x16x32_bf16 v[132:135], v[84:87], v[24:27], v[132:135]
    s_mov_b32 s36, 4096
    buffer_load_dwordx4 v[44:47], v6, s[8:11], s36 offen offset:3072
    s_add_u32 s32, s3, 48
    s_mul_i32 s33, s32, 43
    s_lshr_b32 s33, s33, 8
    s_mul_i32 s34, s33, 6
    s_sub_u32 s34, s32, s34
    s_lshr_b32 s35, s34, 1
    s_lshl_b32 s35, s35, 2
    s_and_b32 s34, s34, 1
    s_add_u32 s34, s34, s35
    s_mul_i32 s34, s34, 14
    s_add_u32 s34, s34, s33
    s_lshl_b32 s34, s34, 10
    s_add_u32 s34, s34, s27
    s_cmp_ge_u32 s32, 84
    s_cselect_b32 s34, 0x7ff00000, s34
    s_lshl_b32 m0, s32, 10
    s_nop 0
    buffer_load_dwordx4 v5, s[16:19], s34 offen lds
    s_mov_b32 s36, 8192
    buffer_load_dwordx4 v[48:51], v6, s[8:11], s36 offen offset:0
    v_mfma_f32_16x16x32_bf16 v[136:139], v[24:27], v[88:91], v[136:139]
    v_mfma_f32_16x16x32_bf16 v[140:143], v[24:27], v[92:95], v[140:143]
    v_mfma_f32_16x16x32_bf16 v[144:147], v[24:27], v[24:27], v[144:147]
    s_waitcnt vmcnt(8)
    s_barrier
    s_waitcnt lgkmcnt(0)
    ds_read_b128 v[80:83], v5 offset:26624
    ds_read_b128 v[84:87], v5 offset:27648
    ds_read_b128 v[88:91], v5 offset:28672
    ds_read_b128 v[92:95], v5 offset:29696
    v_mfma_f32_16x16x32_bf16 v[128:131], v[104:107], v[28:31], v[128:131]
    v_mfma_f32_16x16x32_bf16 v[132:135], v[108:111], v[28:31], v[132:135]
    s_add_u32 s32, s3, 56
    s_mul_i32 s33, s32, 43
    s_lshr_b32 s33, s33, 8
    s_mul_i32 s34, s33, 6
    s_sub_u32 s34, s32, s34
    s_lshr_b32 s35, s34, 1
    s_lshl_b32 s35, s35, 2
    s_and_b32 s34, s34, 1
    s_add_u32 s34, s34, s35
    s_mul_i32 s34, s34, 14
    s_add_u32 s34, s34, s33
    s_lshl_b32 s34, s34, 10
    s_add_u32 s34, s34, s27
    s_cmp_ge_u32 s32, 84
    s_cselect_b32 s34, 0x7ff00000, s34
    s_lshl_b32 m0, s32, 10
    s_nop 0
    buffer_load_dwordx4 v5, s[16:19], s34 offen lds
    s_mov_b32 s36, 8192
    buffer_load_dwordx4 v[52:55], v6, s[8:11], s36 offen offset:1024
    s_add_u32 s32, s3, 64
    s_mul_i32 s33, s32, 43
    s_lshr_b32 s33, s33, 8
    s_mul_i32 s34, s33, 6
    s_sub_u32 s34, s32, s34
    s_lshr_b32 s35, s34, 1
    s_lshl_b32 s35, s35, 2
    s_and_b32 s34, s34, 1
    s_add_u32 s34, s34, s35
    s_mul_i32 s34, s34, 14
    s_add_u32 s34, s34, s33
    s_lshl_b32 s34, s34, 10
    s_add_u32 s34, s34, s27
    s_cmp_ge_u32 s32, 84
    s_cselect_b32 s34, 0x7ff00000, s34
    s_lshl_b32 m0, s32, 10
    s_nop 0
    buffer_load_dwordx4 v5, s[16:19], s34 offen lds
    s_mov_b32 s36, 8192
    buffer_load_dwordx4 v[56:59], v6, s[8:11], s36 offen offset:2048
    v_mfma_f32_16x16x32_bf16 v[136:139], v[28:31], v[112:115], v[136:139]
    v_mfma_f32_16x16x32_bf16 v[140:143], v[28:31], v[116:119], v[140:143]
    v_mfma_f32_16x16x32_bf16 v[144:147], v[28:31], v[28:31], v[144:147]
    s_waitcnt vmcnt(10)
    s_barrier
    s_waitcnt lgkmcnt(0)
    ds_read_b128 v[104:107], v5 offset:32768
    ds_read_b128 v[108:111], v5 offset:33792
    ds_read_b128 v[112:115], v5 offset:34816
    ds_read_b128 v[116:119], v5 offset:35840
    v_mfma_f32_16x16x32_bf16 v[128:131], v[80:83], v[32:35], v[128:131]
    v_mfma_f32_16x16x32_bf16 v[132:135], v[84:87], v[32:35], v[132:135]
    s_mov_b32 s36, 8192
    buffer_load_dwordx4 v[60:63], v6, s[8:11], s36 offen offset:3072
    s_add_u32 s32, s3, 72
    s_mul_i32 s33, s32, 43
    s_lshr_b32 s33, s33, 8
    s_mul_i32 s34, s33, 6
    s_sub_u32 s34, s32, s34
    s_lshr_b32 s35, s34, 1
    s_lshl_b32 s35, s35, 2
    s_and_b32 s34, s34, 1
    s_add_u32 s34, s34, s35
    s_mul_i32 s34, s34, 14
    s_add_u32 s34, s34, s33
    s_lshl_b32 s34, s34, 10
    s_add_u32 s34, s34, s27
    s_cmp_ge_u32 s32, 84
    s_cselect_b32 s34, 0x7ff00000, s34
    s_lshl_b32 m0, s32, 10
    s_nop 0
    buffer_load_dwordx4 v5, s[16:19], s34 offen lds
    s_mov_b32 s36, 12288
    buffer_load_dwordx4 v[64:67], v6, s[8:11], s36 offen offset:0
    v_mfma_f32_16x16x32_bf16 v[136:139], v[32:35], v[88:91], v[136:139]
    v_mfma_f32_16x16x32_bf16 v[140:143], v[32:35], v[92:95], v[140:143]
    v_mfma_f32_16x16x32_bf16 v[144:147], v[32:35], v[32:35], v[144:147]
    s_waitcnt vmcnt(11)
    s_barrier
    s_waitcnt lgkmcnt(0)
    ds_read_b128 v[80:83], v5 offset:38912
    ds_read_b128 v[84:87], v5 offset:39936
    ds_read_b128 v[88:91], v5 offset:40960
    ds_read_b128 v[92:95], v5 offset:41984
    v_mfma_f32_16x16x32_bf16 v[128:131], v[104:107], v[36:39], v[128:131]
    v_mfma_f32_16x16x32_bf16 v[132:135], v[108:111], v[36:39], v[132:135]
    s_add_u32 s32, s3, 80
    s_mul_i32 s33, s32, 43
    s_lshr_b32 s33, s33, 8
    s_mul_i32 s34, s33, 6
    s_sub_u32 s34, s32, s34
    s_lshr_b32 s35, s34, 1
    s_lshl_b32 s35, s35, 2
    s_and_b32 s34, s34, 1
    s_add_u32 s34, s34, s35
    s_mul_i32 s34, s34, 14
    s_add_u32 s34, s34, s33
    s_lshl_b32 s34, s34, 10
    s_add_u32 s34, s34, s27
    s_cmp_ge_u32 s32, 84
    s_cselect_b32 s34, 0x7ff00000, s34
    s_lshl_b32 m0, s32, 10
    s_nop 0
    buffer_load_dwordx4 v5, s[16:19], s34 offen lds
    s_mov_b32 s36, 12288
    buffer_load_dwordx4 v[68:71], v6, s[8:11], s36 offen offset:1024
    v_mfma_f32_16x16x32_bf16 v[136:139], v[36:39], v[112:115], v[136:139]
    v_mfma_f32_16x16x32_bf16 v[140:143], v[36:39], v[116:119], v[140:143]
    v_mfma_f32_16x16x32_bf16 v[144:147], v[36:39], v[36:39], v[144:147]
    s_waitcnt vmcnt(12)
    s_waitcnt lgkmcnt(0)
    ds_read_b128 v[104:107], v5 offset:45056
    ds_read_b128 v[108:111], v5 offset:46080
    ds_read_b128 v[112:115], v5 offset:47104
    ds_read_b128 v[116:119], v5 offset:48128
    v_mfma_f32_16x16x32_bf16 v[128:131], v[80:83], v[40:43], v[128:131]
    v_mfma_f32_16x16x32_bf16 v[132:135], v[84:87], v[40:43], v[132:135]
    v_mfma_f32_16x16x32_bf16 v[136:139], v[40:43], v[88:91], v[136:139]
    v_mfma_f32_16x16x32_bf16 v[140:143], v[40:43], v[92:95], v[140:143]
    v_mfma_f32_16x16x32_bf16 v[144:147], v[40:43], v[40:43], v[144:147]
    s_waitcnt vmcnt(10)
    s_barrier
    s_waitcnt lgkmcnt(0)
    ds_read_b128 v[80:83], v14 offset:2048
    ds_read_b128 v[84:87], v14 offset:3072
    ds_read_b128 v[88:91], v14 offset:4096
    ds_read_b128 v[92:95], v14 offset:5120
    v_mfma_f32_16x16x32_bf16 v[128:131], v[104:107], v[44:47], v[128:131]
    v_mfma_f32_16x16x32_bf16 v[132:135], v[108:111], v[44:47], v[132:135]
    v_mfma_f32_16x16x32_bf16 v[136:139], v[44:47], v[112:115], v[136:139]
    v_mfma_f32_16x16x32_bf16 v[140:143], v[44:47], v[116:119], v[140:143]
    v_mfma_f32_16x16x32_bf16 v[144:147], v[44:47], v[44:47], v[144:147]
    s_waitcnt vmcnt(8)
    s_barrier
    s_waitcnt lgkmcnt(0)
    ds_read_b128 v[104:107], v14 offset:8192
    ds_read_b128 v[108:111], v14 offset:9216
    ds_read_b128 v[112:115], v14 offset:10240
    ds_read_b128 v[116:119], v14 offset:11264
    v_mfma_f32_16x16x32_bf16 v[128:131], v[80:83], v[48:51], v[128:131]
    v_mfma_f32_16x16x32_bf16 v[132:135], v[84:87], v[48:51], v[132:135]
    v_mfma_f32_16x16x32_bf16 v[136:139], v[48:51], v[88:91], v[136:139]
    v_mfma_f32_16x16x32_bf16 v[140:143], v[48:51], v[92:95], v[140:143]
    v_mfma_f32_16x16x32_bf16 v[144:147], v[48:51], v[48:51], v[144:147]
    s_waitcnt vmcnt(6)
    s_barrier
    s_waitcnt lgkmcnt(0)
    ds_read_b128 v[80:83], v14 offset:14336
    ds_read_b128 v[84:87], v14 offset:15360
    ds_read_b128 v[88:91], v14 offset:16384
    ds_read_b128 v[92:95], v14 offset:17408
    v_mfma_f32_16x16x32_bf16 v[128:131], v[104:107], v[52:55], v[128:131]
    v_mfma_f32_16x16x32_bf16 v[132:135], v[108:111], v[52:55], v[132:135]
    v_mfma_f32_16x16x32_bf16 v[136:139], v[52:55], v[112:115], v[136:139]
    v_mfma_f32_16x16x32_bf16 v[140:143], v[52:55], v[116:119], v[140:143]
    v_mfma_f32_16x16x32_bf16 v[144:147], v[52:55], v[52:55], v[144:147]
    s_waitcnt vmcnt(5)
    s_waitcnt lgkmcnt(0)
    ds_read_b128 v[104:107], v14 offset:20480
    ds_read_b128 v[108:111], v14 offset:21504
    ds_read_b128 v[112:115], v14 offset:22528
    ds_read_b128 v[116:119], v14 offset:23552
    v_mfma_f32_16x16x32_bf16 v[128:131], v[80:83], v[56:59], v[128:131]
    v_mfma_f32_16x16x32_bf16 v[132:135], v[84:87], v[56:59], v[132:135]
    v_mfma_f32_16x16x32_bf16 v[136:139], v[56:59], v[88:91], v[136:139]
    v_mfma_f32_16x16x32_bf16 v[140:143], v[56:59], v[92:95], v[140:143]
    v_mfma_f32_16x16x32_bf16 v[144:147], v[56:59], v[56:59], v[144:147]
    s_waitcnt vmcnt(3)
    s_barrier
    s_waitcnt lgkmcnt(0)
    ds_read_b128 v[80:83], v14 offset:26624
    ds_read_b128 v[84:87], v14 offset:27648
    ds_read_b128 v[88:91], v14 offset:28672
    ds_read_b128 v[92:95], v14 offset:29696
    v_mfma_f32_16x16x32_bf16 v[128:131], v[104:107], v[60:63], v[128:131]
    v_mfma_f32_16x16x32_bf16 v[132:135], v[108:111], v[60:63], v[132:135]
    v_mfma_f32_16x16x32_bf16 v[136:139], v[60:63], v[112:115], v[136:139]
    v_mfma_f32_16x16x32_bf16 v[140:143], v[60:63], v[116:119], v[140:143]
    v_mfma_f32_16x16x32_bf16 v[144:147], v[60:63], v[60:63], v[144:147]
    s_waitcnt vmcnt(1)
    s_barrier
    s_waitcnt lgkmcnt(0)
    ds_read_b128 v[104:107], v14 offset:32768
    ds_read_b128 v[108:111], v14 offset:33792
    ds_read_b128 v[112:115], v14 offset:34816
    ds_read_b128 v[116:119], v14 offset:35840
    v_mfma_f32_16x16x32_bf16 v[128:131], v[80:83], v[64:67], v[128:131]
    v_mfma_f32_16x16x32_bf16 v[132:135], v[84:87], v[64:67], v[132:135]
    v_mfma_f32_16x16x32_bf16 v[136:139], v[64:67], v[88:91], v[136:139]
    v_mfma_f32_16x16x32_bf16 v[140:143], v[64:67], v[92:95], v[140:143]
    v_mfma_f32_16x16x32_bf16 v[144:147], v[64:67], v[64:67], v[144:147]
    s_waitcnt vmcnt(0)
    s_waitcnt lgkmcnt(0)
    v_mfma_f32_16x16x32_bf16 v[128:131], v[104:107], v[68:71], v[128:131]
    v_mfma_f32_16x16x32_bf16 v[132:135], v[108:111], v[68:71], v[132:135]
    v_mfma_f32_16x16x32_bf16 v[136:139], v[68:71], v[112:115], v[136:139]
    v_mfma_f32_16x16x32_bf16 v[140:143], v[68:71], v[116:119], v[140:143]
    v_mfma_f32_16x16x32_bf16 v[144:147], v[68:71], v[68:71], v[144:147]
    s_nop 7
    s_nop 1
    v_and_b32 v166, 3, v3
    v_lshrrev_b32 v167, 2, v3
    v_lshl_add_u32 v167, v167, 4, v3
    v_lshlrev_b32 v167, 2, v167
    v_add_u32 v168, 48, v3
    v_lshlrev_b32 v168, 2, v168
    v_cmp_eq_u32 s[40:41], 1, v166
    v_cmp_eq_u32 s[42:43], 2, v166
    v_cmp_eq_u32 s[44:45], 3, v166
    s_nop 1
    v_cndmask_b32 v144, v144, v145, s[40:41]
    v_cndmask_b32 v144, v144, v146, s[42:43]
    v_cndmask_b32 v144, v144, v147, s[44:45]
    ds_bpermute_b32 v145, v167, v144
    ds_bpermute_b32 v146, v168, v132
    s_lshl_b32 s32, s3, 9
    s_add_u32 s32, s32, 147456
    v_lshl_add_u32 v169, v3, 3, s32
    v_lshl_add_u32 v170, v2, 5, s32
    s_waitcnt lgkmcnt(0)
    v_mul_f32 v144, 0x3b124925, v146
    v_mul_f32 v145, 0x3b124925, v145
    v_fma_f32 v145, -v144, v144, v145
    v_max_f32 v145, 0, v145
    v_cvt_pk_bf16_f32 v145, v145, v145
    v_lshlrev_b32 v145, 16, v145
    v_add_f32 v145, 0x3727c5ac, v145
    v_cvt_pk_bf16_f32 v145, v145, v145
    v_lshlrev_b32 v145, 16, v145
    v_sqrt_f32 v145, v145
    s_nop 0
    v_cvt_pk_bf16_f32 v145, v145, v145
    v_lshlrev_b32 v145, 16, v145
    v_rcp_f32 v145, v145
    v_cvt_pk_bf16_f32 v144, v144, v144
    v_lshlrev_b32 v144, 16, v144
    ds_write_b64 v169, v[144:145]
    s_waitcnt lgkmcnt(0)
    ds_read_b128 v[72:75], v170
    ds_read_b128 v[76:79], v170 offset:16
    v_cmp_eq_u32 s[40:41], 3, v2
    v_cmp_eq_u32 s[42:43], 12, v3
    v_mov_b32 v166, 0x3f803f80
    s_nop 0
    v_cndmask_b32 v166, 0, v166, s[42:43]
    v_pk_fma_f32 v[128:129], v[156:157], v[144:145], v[128:129] op_sel:[0,0,0] op_sel_hi:[1,0,1] neg_lo:[0,1,0] neg_hi:[0,1,0]
    v_pk_mul_f32 v[128:129], v[128:129], v[144:145] op_sel:[0,1] op_sel_hi:[1,1]
    v_cvt_pk_bf16_f32 v200, v128, v129
    v_pk_fma_f32 v[130:131], v[158:159], v[144:145], v[130:131] op_sel:[0,0,0] op_sel_hi:[1,0,1] neg_lo:[0,1,0] neg_hi:[0,1,0]
    v_pk_mul_f32 v[130:131], v[130:131], v[144:145] op_sel:[0,1] op_sel_hi:[1,1]
    v_cvt_pk_bf16_f32 v201, v130, v131
    v_pk_fma_f32 v[132:133], v[160:161], v[144:145], v[132:133] op_sel:[0,0,0] op_sel_hi:[1,0,1] neg_lo:[0,1,0] neg_hi:[0,1,0]
    v_pk_mul_f32 v[132:133], v[132:133], v[144:145] op_sel:[0,1] op_sel_hi:[1,1]
    v_cvt_pk_bf16_f32 v202, v132, v133
    v_pk_fma_f32 v[134:135], v[162:163], v[144:145], v[134:135] op_sel:[0,0,0] op_sel_hi:[1,0,1] neg_lo:[0,1,0] neg_hi:[0,1,0]
    v_pk_mul_f32 v[134:135], v[134:135], v[144:145] op_sel:[0,1] op_sel_hi:[1,1]
    v_cvt_pk_bf16_f32 v203, v134, v135
    v_cndmask_b32 v202, v202, 0, s[40:41]
    v_cndmask_b32 v203, v203, 0, s[40:41]
    s_lshl_b32 s32, s3, 10
    s_add_u32 s33, s32, 114688
    v_add_u32 v168, s33, v5
    ds_write_b128 v168, v[200:203]
    s_lshl_b32 s33, s23, 10
    buffer_store_dwordx4 v[200:203], v5, s[80:83], s33 offen sc0 sc1
    s_waitcnt lgkmcnt(1)
    v_fma_f32 v136, -v72, v164, v136
    v_mul_f32 v136, v136, v73
    v_fma_f32 v137, -v74, v164, v137
    v_mul_f32 v137, v137, v75
    v_fma_f32 v138, -v76, v164, v138
    v_mul_f32 v138, v138, v77
    v_fma_f32 v139, -v78, v164, v139
    v_mul_f32 v139, v139, v79
    v_cvt_pk_bf16_f32 v208, v136, v137
    v_cvt_pk_bf16_f32 v209, v138, v139
    v_fma_f32 v140, -v72, v165, v140
    v_mul_f32 v140, v140, v73
    v_fma_f32 v141, -v74, v165, v141
    v_mul_f32 v141, v141, v75
    v_fma_f32 v142, -v76, v165, v142
    v_mul_f32 v142, v142, v77
    v_fma_f32 v143, -v78, v165, v143
    v_mul_f32 v143, v143, v79
    v_cvt_pk_bf16_f32 v210, v140, v141
    v_cvt_pk_bf16_f32 v211, v142, v143
    v_or_b32 v210, v210, v166
    v_or_b32 v211, v211, v166
    s_lshr_b32 s33, s3, 1
    s_lshl_b32 s33, s33, 10
    s_and_b32 s34, s3, 1
    s_lshl_b32 s34, s34, 3
    s_add_u32 s33, s33, s34
    s_add_u32 s35, s33, 131072
    v_add_u32 v169, s35, v5
    ds_write_b64 v169, v[208:209]
    ds_write_b64 v169, v[210:211] offset:12288
    s_lshl_b32 s35, s21, 12
    s_add_u32 s35, s35, s33
    buffer_store_dwordx2 v[208:209], v5, s[84:87], s35 offen sc0 sc1
    buffer_store_dwordx2 v[210:211], v5, s[88:91], s35 offen sc0 sc1
    s_waitcnt vmcnt(0) lgkmcnt(0)
    s_barrier
    s_cmp_lg_u32 s3, 0
    s_cbranch_scc1 qa_kernel_w2
    s_lshl_b32 s32, s20, 4
    s_add_u32 s32, s32, s21
    s_lshl_b32 s32, s32, 6
    v_mov_b32 v168, s32
    v_mov_b32 v169, 1
    s_mov_b64 s[44:45], exec
    s_mov_b64 exec, 1
    buffer_atomic_add v169, v168, s[92:95], 0 offen sc1
    s_mov_b64 exec, s[44:45]
qa_kernel_w2:
    ds_read_b128 v[72:75], v5 offset:0
    ds_read_b128 v[76:79], v5 offset:1024
    ds_read_b128 v[80:83], v5 offset:6144
    ds_read_b128 v[84:87], v5 offset:7168
    ds_read_b128 v[88:91], v5 offset:12288
    ds_read_b128 v[92:95], v5 offset:13312
    ds_read_b128 v[96:99], v5 offset:18432
    ds_read_b128 v[100:103], v5 offset:19456
    s_waitcnt lgkmcnt(6)
    v_mfma_f32_16x16x32_bf16 v[120:123], v[72:75], v[16:19], 0
    v_mfma_f32_16x16x32_bf16 v[124:127], v[76:79], v[16:19], 0
    ds_read_b128 v[72:75], v5 offset:24576
    ds_read_b128 v[76:79], v5 offset:25600
    s_waitcnt lgkmcnt(6)
    v_mfma_f32_16x16x32_bf16 v[120:123], v[80:83], v[20:23], v[120:123]
    v_mfma_f32_16x16x32_bf16 v[124:127], v[84:87], v[20:23], v[124:127]
    ds_read_b128 v[80:83], v5 offset:30720
    ds_read_b128 v[84:87], v5 offset:31744
    s_waitcnt lgkmcnt(6)
    v_mfma_f32_16x16x32_bf16 v[120:123], v[88:91], v[24:27], v[120:123]
    v_mfma_f32_16x16x32_bf16 v[124:127], v[92:95], v[24:27], v[124:127]
    ds_read_b128 v[88:91], v5 offset:36864
    ds_read_b128 v[92:95], v5 offset:37888
    s_waitcnt lgkmcnt(6)
    v_mfma_f32_16x16x32_bf16 v[120:123], v[96:99], v[28:31], v[120:123]
    v_mfma_f32_16x16x32_bf16 v[124:127], v[100:103], v[28:31], v[124:127]
    ds_read_b128 v[96:99], v5 offset:43008
    ds_read_b128 v[100:103], v5 offset:44032
    s_waitcnt lgkmcnt(6)
    v_mfma_f32_16x16x32_bf16 v[120:123], v[72:75], v[32:35], v[120:123]
    v_mfma_f32_16x16x32_bf16 v[124:127], v[76:79], v[32:35], v[124:127]
    ds_read_b128 v[72:75], v14 offset:0
    ds_read_b128 v[76:79], v14 offset:1024
    s_waitcnt lgkmcnt(6)
    v_mfma_f32_16x16x32_bf16 v[120:123], v[80:83], v[36:39], v[120:123]
    v_mfma_f32_16x16x32_bf16 v[124:127], v[84:87], v[36:39], v[124:127]
    ds_read_b128 v[80:83], v14 offset:6144
    ds_read_b128 v[84:87], v14 offset:7168
    s_waitcnt lgkmcnt(6)
    v_mfma_f32_16x16x32_bf16 v[120:123], v[88:91], v[40:43], v[120:123]
    v_mfma_f32_16x16x32_bf16 v[124:127], v[92:95], v[40:43], v[124:127]
    ds_read_b128 v[88:91], v14 offset:12288
    ds_read_b128 v[92:95], v14 offset:13312
    s_waitcnt lgkmcnt(6)
    v_mfma_f32_16x16x32_bf16 v[120:123], v[96:99], v[44:47], v[120:123]
    v_mfma_f32_16x16x32_bf16 v[124:127], v[100:103], v[44:47], v[124:127]
    ds_read_b128 v[96:99], v14 offset:18432
    ds_read_b128 v[100:103], v14 offset:19456
    s_waitcnt lgkmcnt(6)
    v_mfma_f32_16x16x32_bf16 v[120:123], v[72:75], v[48:51], v[120:123]
    v_mfma_f32_16x16x32_bf16 v[124:127], v[76:79], v[48:51], v[124:127]
    ds_read_b128 v[72:75], v14 offset:24576
    ds_read_b128 v[76:79], v14 offset:25600
    s_waitcnt lgkmcnt(6)
    v_mfma_f32_16x16x32_bf16 v[120:123], v[80:83], v[52:55], v[120:123]
    v_mfma_f32_16x16x32_bf16 v[124:127], v[84:87], v[52:55], v[124:127]
    ds_read_b128 v[80:83], v14 offset:30720
    ds_read_b128 v[84:87], v14 offset:31744
    s_waitcnt lgkmcnt(6)
    v_mfma_f32_16x16x32_bf16 v[120:123], v[88:91], v[56:59], v[120:123]
    v_mfma_f32_16x16x32_bf16 v[124:127], v[92:95], v[56:59], v[124:127]
    s_waitcnt lgkmcnt(4)
    v_mfma_f32_16x16x32_bf16 v[120:123], v[96:99], v[60:63], v[120:123]
    v_mfma_f32_16x16x32_bf16 v[124:127], v[100:103], v[60:63], v[124:127]
    s_waitcnt lgkmcnt(2)
    v_mfma_f32_16x16x32_bf16 v[120:123], v[72:75], v[64:67], v[120:123]
    v_mfma_f32_16x16x32_bf16 v[124:127], v[76:79], v[64:67], v[124:127]
    s_waitcnt lgkmcnt(0)
    v_mfma_f32_16x16x32_bf16 v[120:123], v[80:83], v[68:71], v[120:123]
    v_mfma_f32_16x16x32_bf16 v[124:127], v[84:87], v[68:71], v[124:127]
    s_nop 7
    s_nop 1
    v_pk_fma_f32 v[120:121], v[148:149], v[144:145], v[120:121] op_sel:[0,0,0] op_sel_hi:[1,0,1] neg_lo:[0,1,0] neg_hi:[0,1,0]
    v_pk_mul_f32 v[120:121], v[120:121], v[144:145] op_sel:[0,1] op_sel_hi:[1,1]
    v_cvt_pk_bf16_f32 v8, v120, v121
    v_pk_fma_f32 v[122:123], v[150:151], v[144:145], v[122:123] op_sel:[0,0,0] op_sel_hi:[1,0,1] neg_lo:[0,1,0] neg_hi:[0,1,0]
    v_pk_mul_f32 v[122:123], v[122:123], v[144:145] op_sel:[0,1] op_sel_hi:[1,1]
    v_cvt_pk_bf16_f32 v9, v122, v123
    v_pk_fma_f32 v[124:125], v[152:153], v[144:145], v[124:125] op_sel:[0,0,0] op_sel_hi:[1,0,1] neg_lo:[0,1,0] neg_hi:[0,1,0]
    v_pk_mul_f32 v[124:125], v[124:125], v[144:145] op_sel:[0,1] op_sel_hi:[1,1]
    v_cvt_pk_bf16_f32 v10, v124, v125
    v_pk_fma_f32 v[126:127], v[154:155], v[144:145], v[126:127] op_sel:[0,0,0] op_sel_hi:[1,0,1] neg_lo:[0,1,0] neg_hi:[0,1,0]
    v_pk_mul_f32 v[126:127], v[126:127], v[144:145] op_sel:[0,1] op_sel_hi:[1,1]
    v_cvt_pk_bf16_f32 v11, v126, v127
    v_mov_b32 v167, 0x3f80
    v_cndmask_b32 v10, v10, v167, s[40:41]
    v_cndmask_b32 v11, v11, 0, s[40:41]
    s_cmp_lg_u32 s3, 0
    s_cbranch_scc1 qa_kernel_w5
    s_mov_b64 exec, 3
    v_add_u32 v170, 1, v0
    v_cmp_ge_u32 vcc, s21, v170
    s_nop 1
    v_cndmask_b32 v170, 0, v170, vcc
    v_lshlrev_b32 v170, 6, v170
    v_sub_u32 v168, s32, v170
    s_mov_b32 s33, 0
qa_kernel_p3:
    buffer_load_dword v169, v168, s[92:95], 0 offen sc0 sc1
    s_waitcnt vmcnt(0)
    v_cmp_le_u32 vcc, 1, v169
    s_add_u32 s33, s33, 1
    s_nop 0
    s_cmp_eq_u32 vcc_lo, 3
    s_cbranch_scc1 qa_kernel_x4
    s_cmp_ge_u32 s33, 0x40000
    s_cbranch_scc1 qa_kernel_x4
    s_sleep 1
    s_branch qa_kernel_p3
qa_kernel_x4:
    s_mov_b64 exec, s[44:45]
qa_kernel_w5:
    s_barrier
    s_lshl_b32 s32, s3, 1
    s_add_u32 s33, s32, s22
    s_sub_u32 s33, s33, 16
    s_lshl_b32 s33, s33, 10
    v_add_u32 v6, s33, v5
    s_lshl_b32 s34, s32, 10
    s_add_u32 m0, s34, 98304
    s_nop 0
    buffer_load_dwordx4 v6, s[80:83], 0 offen sc0 sc1 lds
    v_add_u32 v6, 1024, v6
    s_add_u32 m0, s34, 99328
    s_nop 0
    buffer_load_dwordx4 v6, s[80:83], 0 offen sc0 sc1 lds
    s_lshl_b32 s33, s21, 2
    s_add_u32 s33, s33, s3
    s_sub_u32 s33, s33, 8
    s_lshl_b32 s33, s33, 10
    v_add_u32 v6, s33, v5
    s_lshl_b32 s34, s3, 10
    s_add_u32 m0, s34, 122880
    s_nop 0
    buffer_load_dwordx4 v6, s[84:87], 0 offen sc0 sc1 lds
    s_add_u32 m0, s34, 135168
    s_nop 0
    buffer_load_dwordx4 v6, s[88:91], 0 offen sc0 sc1 lds
    s_and_b32 s36, s3, 1
    s_lshl_b32 s37, s36, 4
    s_add_u32 s37, s37, 256
    v_lshlrev_b32 v14, 2, v2
    v_sub_u32 v14, v3, v14
    v_add_u32 v14, s37, v14
    s_and_b32 s38, s3, 6
    s_lshl_b32 s39, s38, 10
    s_add_u32 s39, s39, 98304
    v_add_u32 v15, s39, v5
    s_lshl_b32 s39, s38, 9
    s_add_u32 s39, s39, 122880
    v_add_u32 v12, s39, v5
    s_waitcnt vmcnt(0)
    s_add_u32 s33, s32, s22
    s_cmp_ge_u32 s33, 16
    s_cbranch_scc1 qa_kernel_m6
    v_mov_b32 v16, 0
    v_mov_b32 v17, 0
    v_mov_b32 v18, 0xff7f
    v_mov_b32 v19, 0
    v_cndmask_b32 v18, 0, v18, s[40:41]
    s_lshl_b32 s34, s32, 10
    s_add_u32 s34, s34, 98304
    v_add_u32 v6, s34, v5
    ds_write_b128 v6, v[16:19]
    ds_write_b128 v6, v[16:19] offset:1024
    s_waitcnt lgkmcnt(0)
qa_kernel_m6:
    s_barrier
    ds_read_b128 v[88:91], v15 offset:0
    ds_read_b128 v[92:95], v15 offset:1024
    ds_read_b128 v[96:99], v15 offset:2048
    ds_read_b128 v[100:103], v15 offset:3072
    ds_read_b128 v[104:107], v15 offset:4096
    ds_read_b128 v[108:111], v15 offset:5120
    s_waitcnt lgkmcnt(5)
    v_mfma_f32_16x16x32_bf16 v[16:19], v[88:91], v[8:11], 0
    ds_read_b128 v[88:91], v15 offset:6144
    s_waitcnt lgkmcnt(5)
    v_mfma_f32_16x16x32_bf16 v[20:23], v[92:95], v[8:11], 0
    ds_read_b128 v[92:95], v15 offset:7168
    s_waitcnt lgkmcnt(5)
    v_mfma_f32_16x16x32_bf16 v[24:27], v[96:99], v[8:11], 0
    ds_read_b128 v[96:99], v15 offset:8192
    s_waitcnt lgkmcnt(5)
    v_mfma_f32_16x16x32_bf16 v[28:31], v[100:103], v[8:11], 0
    ds_read_b128 v[100:103], v15 offset:9216
    s_waitcnt lgkmcnt(5)
    v_mfma_f32_16x16x32_bf16 v[32:35], v[104:107], v[8:11], 0
    ds_read_b128 v[104:107], v15 offset:10240
    s_waitcnt lgkmcnt(5)
    v_mfma_f32_16x16x32_bf16 v[36:39], v[108:111], v[8:11], 0
    ds_read_b128 v[108:111], v15 offset:11264
    s_waitcnt lgkmcnt(5)
    v_mfma_f32_16x16x32_bf16 v[40:43], v[88:91], v[8:11], 0
    ds_read_b128 v[88:91], v15 offset:12288
    s_waitcnt lgkmcnt(5)
    v_mfma_f32_16x16x32_bf16 v[44:47], v[92:95], v[8:11], 0
    ds_read_b128 v[92:95], v15 offset:13312
    s_waitcnt lgkmcnt(5)
    v_mfma_f32_16x16x32_bf16 v[48:51], v[96:99], v[8:11], 0
    ds_read_b128 v[96:99], v15 offset:14336
    s_waitcnt lgkmcnt(5)
    v_mfma_f32_16x16x32_bf16 v[52:55], v[100:103], v[8:11], 0
    ds_read_b128 v[100:103], v15 offset:15360
    s_waitcnt lgkmcnt(5)
    v_mfma_f32_16x16x32_bf16 v[56:59], v[104:107], v[8:11], 0
    ds_read_b128 v[104:107], v15 offset:16384
    s_waitcnt lgkmcnt(5)
    v_mfma_f32_16x16x32_bf16 v[60:63], v[108:111], v[8:11], 0
    ds_read_b128 v[108:111], v15 offset:17408
    s_waitcnt lgkmcnt(5)
    v_mfma_f32_16x16x32_bf16 v[64:67], v[88:91], v[8:11], 0
    s_waitcnt lgkmcnt(4)
    v_mfma_f32_16x16x32_bf16 v[68:71], v[92:95], v[8:11], 0
    s_waitcnt lgkmcnt(3)
    v_mfma_f32_16x16x32_bf16 v[72:75], v[96:99], v[8:11], 0
    s_waitcnt lgkmcnt(2)
    v_mfma_f32_16x16x32_bf16 v[76:79], v[100:103], v[8:11], 0
    s_waitcnt lgkmcnt(1)
    v_mfma_f32_16x16x32_bf16 v[80:83], v[104:107], v[8:11], 0
    s_waitcnt lgkmcnt(0)
    v_mfma_f32_16x16x32_bf16 v[84:87], v[108:111], v[8:11], 0
    ds_read_b128 v[112:115], v12 offset:0
    ds_read_b128 v[116:119], v12 offset:12288
    ds_read_b128 v[120:123], v12 offset:1024
    ds_read_b128 v[124:127], v12 offset:13312
    ds_read_b128 v[128:131], v12 offset:2048
    ds_read_b128 v[132:135], v12 offset:14336
    ds_read_b128 v[136:139], v12 offset:3072
    ds_read_b128 v[140:143], v12 offset:15360
    ds_read_b128 v[144:147], v12 offset:4096
    ds_read_b128 v[148:151], v12 offset:16384
    ds_read_b128 v[152:155], v12 offset:5120
    ds_read_b128 v[156:159], v12 offset:17408
    ds_read_b128 v[160:163], v12 offset:6144
    ds_read_b128 v[164:167], v12 offset:18432
    ds_read_b128 v[168:171], v12 offset:7168
    ds_read_b128 v[172:175], v12 offset:19456
    ds_read_b128 v[176:179], v12 offset:8192
    ds_read_b128 v[180:183], v12 offset:20480
    v_mov_b32 v13, 0xff7fffff
    s_mov_b32 s32, 255
    v_cmp_ge_u32 s[64:65], s32, v14
    s_mov_b32 s32, 256
    v_cmp_ge_u32 s[66:67], s32, v14
    s_mov_b32 s32, 257
    v_cmp_ge_u32 s[68:69], s32, v14
    s_mov_b32 s32, 258
    v_cmp_ge_u32 s[70:71], s32, v14
    s_mov_b32 s32, 271
    v_cmp_ge_u32 s[72:73], s32, v14
    s_mov_b32 s32, 272
    v_cmp_ge_u32 s[74:75], s32, v14
    s_mov_b32 s32, 273
    v_cmp_ge_u32 s[76:77], s32, v14
    s_mov_b32 s32, 274
    v_cmp_ge_u32 s[78:79], s32, v14
    s_mov_b32 s32, 256
    v_cmp_le_u32 s[80:81], s32, v14
    s_mov_b32 s32, 257
    v_cmp_le_u32 s[82:83], s32, v14
    s_mov_b32 s32, 258
    v_cmp_le_u32 s[84:85], s32, v14
    s_mov_b32 s32, 259
    v_cmp_le_u32 s[86:87], s32, v14
    s_mov_b32 s32, 272
    v_cmp_le_u32 s[88:89], s32, v14
    s_mov_b32 s32, 273
    v_cmp_le_u32 s[90:91], s32, v14
    s_mov_b32 s32, 274
    v_cmp_le_u32 s[92:93], s32, v14
    s_mov_b32 s32, 275
    v_cmp_le_u32 s[94:95], s32, v14
    s_nop 1
    v_cndmask_b32 v16, v13, v16, s[64:65]
    v_cndmask_b32 v17, v13, v17, s[66:67]
    v_cndmask_b32 v18, v13, v18, s[68:69]
    v_cndmask_b32 v19, v13, v19, s[70:71]
    v_cndmask_b32 v20, v13, v20, s[72:73]
    v_cndmask_b32 v21, v13, v21, s[74:75]
    v_cndmask_b32 v22, v13, v22, s[76:77]
    v_cndmask_b32 v23, v13, v23, s[78:79]
    v_cndmask_b32 v80, v13, v80, s[80:81]
    v_cndmask_b32 v81, v13, v81, s[82:83]
    v_cndmask_b32 v82, v13, v82, s[84:85]
    v_cndmask_b32 v83, v13, v83, s[86:87]
    v_cndmask_b32 v84, v13, v84, s[88:89]
    v_cndmask_b32 v85, v13, v85, s[90:91]
    v_cndmask_b32 v86, v13, v86, s[92:93]
    v_cndmask_b32 v87, v13, v87, s[94:95]
    v_max3_f32 v6, v16, v17, v18
    v_max3_f32 v7, v19, v20, v21
    v_max3_f32 v6, v6, v22, v23
    v_max3_f32 v7, v7, v24, v25
    v_max3_f32 v6, v6, v26, v27
    v_max3_f32 v7, v7, v28, v29
    v_max3_f32 v6, v6, v30, v31
    v_max3_f32 v7, v7, v32, v33
    v_max3_f32 v6, v6, v34, v35
    v_max3_f32 v7, v7, v36, v37
    v_max3_f32 v6, v6, v38, v39
    v_max3_f32 v7, v7, v40, v41
    v_max3_f32 v6, v6, v42, v43
    v_max3_f32 v7, v7, v44, v45
    v_max3_f32 v6, v6, v46, v47
    v_max3_f32 v7, v7, v48, v49
    v_max3_f32 v6, v6, v50, v51
    v_max3_f32 v7, v7, v52, v53
    v_max3_f32 v6, v6, v54, v55
    v_max3_f32 v7, v7, v56, v57
    v_max3_f32 v6, v6, v58, v59
    v_max3_f32 v7, v7, v60, v61
    v_max3_f32 v6, v6, v62, v63
    v_max3_f32 v7, v7, v64, v65
    v_max3_f32 v6, v6, v66, v67
    v_max3_f32 v7, v7, v68, v69
    v_max3_f32 v6, v6, v70, v71
    v_max3_f32 v7, v7, v72, v73
    v_max3_f32 v6, v6, v74, v75
    v_max3_f32 v7, v7, v76, v77
    v_max3_f32 v6, v6, v78, v79
    v_max3_f32 v7, v7, v80, v81
    v_max3_f32 v6, v6, v82, v83
    v_max3_f32 v7, v7, v84, v85
    v_max3_f32 v6, v6, v86, v87
    v_max_f32 v6, v6, v7
    v_mov_b32 v7, v6
    s_nop 1
    v_permlane16_swap_b32 v7, v6
    v_max_f32 v6, v7, v6
    v_mov_b32 v7, v6
    s_nop 1
    v_permlane32_swap_b32 v7, v6
    v_max_f32 v6, v7, v6
    s_mov_b32 s40, 0x3e8b97f6
    v_mul_f32 v6, s40, v6
    v_fma_f32 v16, v16, s40, -v6
    v_fma_f32 v17, v17, s40, -v6
    v_fma_f32 v18, v18, s40, -v6
    v_fma_f32 v19, v19, s40, -v6
    v_fma_f32 v20, v20, s40, -v6
    v_fma_f32 v21, v21, s40, -v6
    v_fma_f32 v22, v22, s40, -v6
    v_fma_f32 v23, v23, s40, -v6
    v_fma_f32 v24, v24, s40, -v6
    v_fma_f32 v25, v25, s40, -v6
    v_fma_f32 v26, v26, s40, -v6
    v_fma_f32 v27, v27, s40, -v6
    v_fma_f32 v28, v28, s40, -v6
    v_fma_f32 v29, v29, s40, -v6
    v_fma_f32 v30, v30, s40, -v6
    v_fma_f32 v31, v31, s40, -v6
    v_fma_f32 v32, v32, s40, -v6
    v_fma_f32 v33, v33, s40, -v6
    v_fma_f32 v34, v34, s40, -v6
    v_fma_f32 v35, v35, s40, -v6
    v_fma_f32 v36, v36, s40, -v6
    v_fma_f32 v37, v37, s40, -v6
    v_fma_f32 v38, v38, s40, -v6
    v_fma_f32 v39, v39, s40, -v6
    v_fma_f32 v40, v40, s40, -v6
    v_fma_f32 v41, v41, s40, -v6
    v_fma_f32 v42, v42, s40, -v6
    v_fma_f32 v43, v43, s40, -v6
    v_fma_f32 v44, v44, s40, -v6
    v_fma_f32 v45, v45, s40, -v6
    v_fma_f32 v46, v46, s40, -v6
    v_fma_f32 v47, v47, s40, -v6
    v_fma_f32 v48, v48, s40, -v6
    v_fma_f32 v49, v49, s40, -v6
    v_fma_f32 v50, v50, s40, -v6
    v_fma_f32 v51, v51, s40, -v6
    v_fma_f32 v52, v52, s40, -v6
    v_fma_f32 v53, v53, s40, -v6
    v_fma_f32 v54, v54, s40, -v6
    v_fma_f32 v55, v55, s40, -v6
    v_fma_f32 v56, v56, s40, -v6
    v_fma_f32 v57, v57, s40, -v6
    v_fma_f32 v58, v58, s40, -v6
    v_fma_f32 v59, v59, s40, -v6
    v_fma_f32 v60, v60, s40, -v6
    v_fma_f32 v61, v61, s40, -v6
    v_fma_f32 v62, v62, s40, -v6
    v_fma_f32 v63, v63, s40, -v6
    v_fma_f32 v64, v64, s40, -v6
    v_fma_f32 v65, v65, s40, -v6
    v_fma_f32 v66, v66, s40, -v6
    v_fma_f32 v67, v67, s40, -v6
    v_fma_f32 v68, v68, s40, -v6
    v_fma_f32 v69, v69, s40, -v6
    v_fma_f32 v70, v70, s40, -v6
    v_fma_f32 v71, v71, s40, -v6
    v_fma_f32 v72, v72, s40, -v6
    v_fma_f32 v73, v73, s40, -v6
    v_fma_f32 v74, v74, s40, -v6
    v_fma_f32 v75, v75, s40, -v6
    v_fma_f32 v76, v76, s40, -v6
    v_fma_f32 v77, v77, s40, -v6
    v_fma_f32 v78, v78, s40, -v6
    v_fma_f32 v79, v79, s40, -v6
    v_fma_f32 v80, v80, s40, -v6
    v_fma_f32 v81, v81, s40, -v6
    v_fma_f32 v82, v82, s40, -v6
    v_fma_f32 v83, v83, s40, -v6
    v_fma_f32 v84, v84, s40, -v6
    v_fma_f32 v85, v85, s40, -v6
    v_fma_f32 v86, v86, s40, -v6
    v_fma_f32 v87, v87, s40, -v6
    v_exp_f32 v16, v16
    v_exp_f32 v17, v17
    v_exp_f32 v18, v18
    v_exp_f32 v19, v19
    v_exp_f32 v20, v20
    v_exp_f32 v21, v21
    v_exp_f32 v22, v22
    v_exp_f32 v23, v23
    v_exp_f32 v24, v24
    v_exp_f32 v25, v25
    v_exp_f32 v26, v26
    v_exp_f32 v27, v27
    v_exp_f32 v28, v28
    v_exp_f32 v29, v29
    v_exp_f32 v30, v30
    v_exp_f32 v31, v31
    v_exp_f32 v32, v32
    v_exp_f32 v33, v33
    v_exp_f32 v34, v34
    v_exp_f32 v35, v35
    v_exp_f32 v36, v36
    v_exp_f32 v37, v37
    v_exp_f32 v38, v38
    v_exp_f32 v39, v39
    v_exp_f32 v40, v40
    v_exp_f32 v41, v41
    v_exp_f32 v42, v42
    v_exp_f32 v43, v43
    v_exp_f32 v44, v44
    v_exp_f32 v45, v45
    v_exp_f32 v46, v46
    v_exp_f32 v47, v47
    v_exp_f32 v48, v48
    v_exp_f32 v49, v49
    v_exp_f32 v50, v50
    v_exp_f32 v51, v51
    v_exp_f32 v52, v52
    v_exp_f32 v53, v53
    v_exp_f32 v54, v54
    v_exp_f32 v55, v55
    v_exp_f32 v56, v56
    v_exp_f32 v57, v57
    v_exp_f32 v58, v58
    v_exp_f32 v59, v59
    v_exp_f32 v60, v60
    v_exp_f32 v61, v61
    v_exp_f32 v62, v62
    v_exp_f32 v63, v63
    v_exp_f32 v64, v64
    v_exp_f32 v65, v65
    v_exp_f32 v66, v66
    v_exp_f32 v67, v67
    v_exp_f32 v68, v68
    v_exp_f32 v69, v69
    v_exp_f32 v70, v70
    v_exp_f32 v71, v71
    v_exp_f32 v72, v72
    v_exp_f32 v73, v73
    v_exp_f32 v74, v74
    v_exp_f32 v75, v75
    v_exp_f32 v76, v76
    v_exp_f32 v77, v77
    v_exp_f32 v78, v78
    v_exp_f32 v79, v79
    v_exp_f32 v80, v80
    v_exp_f32 v81, v81
    v_exp_f32 v82, v82
    v_exp_f32 v83, v83
    v_exp_f32 v84, v84
    v_exp_f32 v85, v85
    v_exp_f32 v86, v86
    v_exp_f32 v87, v87
    s_nop 0
    v_cvt_pk_bf16_f32 v184, v16, v17
    v_cvt_pk_bf16_f32 v185, v18, v19
    v_cvt_pk_bf16_f32 v186, v20, v21
    v_cvt_pk_bf16_f32 v187, v22, v23
    v_cvt_pk_bf16_f32 v188, v24, v25
    v_cvt_pk_bf16_f32 v189, v26, v27
    v_cvt_pk_bf16_f32 v190, v28, v29
    v_cvt_pk_bf16_f32 v191, v30, v31
    v_cvt_pk_bf16_f32 v192, v32, v33
    v_cvt_pk_bf16_f32 v193, v34, v35
    v_cvt_pk_bf16_f32 v194, v36, v37
    v_cvt_pk_bf16_f32 v195, v38, v39
    v_cvt_pk_bf16_f32 v196, v40, v41
    v_cvt_pk_bf16_f32 v197, v42, v43
    v_cvt_pk_bf16_f32 v198, v44, v45
    v_cvt_pk_bf16_f32 v199, v46, v47
    v_cvt_pk_bf16_f32 v200, v48, v49
    v_cvt_pk_bf16_f32 v201, v50, v51
    v_cvt_pk_bf16_f32 v202, v52, v53
    v_cvt_pk_bf16_f32 v203, v54, v55
    v_cvt_pk_bf16_f32 v204, v56, v57
    v_cvt_pk_bf16_f32 v205, v58, v59
    v_cvt_pk_bf16_f32 v206, v60, v61
    v_cvt_pk_bf16_f32 v207, v62, v63
    v_cvt_pk_bf16_f32 v208, v64, v65
    v_cvt_pk_bf16_f32 v209, v66, v67
    v_cvt_pk_bf16_f32 v210, v68, v69
    v_cvt_pk_bf16_f32 v211, v70, v71
    v_cvt_pk_bf16_f32 v212, v72, v73
    v_cvt_pk_bf16_f32 v213, v74, v75
    v_cvt_pk_bf16_f32 v214, v76, v77
    v_cvt_pk_bf16_f32 v215, v78, v79
    v_cvt_pk_bf16_f32 v216, v80, v81
    v_cvt_pk_bf16_f32 v217, v82, v83
    v_cvt_pk_bf16_f32 v218, v84, v85
    v_cvt_pk_bf16_f32 v219, v86, v87
    s_waitcnt lgkmcnt(0)
    s_nop 1
    v_mfma_f32_16x16x32_bf16 v[220:223], v[112:115], v[184:187], 0
    v_mfma_f32_16x16x32_bf16 v[224:227], v[116:119], v[184:187], 0
    v_mfma_f32_16x16x32_bf16 v[220:223], v[120:123], v[188:191], v[220:223]
    v_mfma_f32_16x16x32_bf16 v[224:227], v[124:127], v[188:191], v[224:227]
    v_mfma_f32_16x16x32_bf16 v[220:223], v[128:131], v[192:195], v[220:223]
    v_mfma_f32_16x16x32_bf16 v[224:227], v[132:135], v[192:195], v[224:227]
    v_mfma_f32_16x16x32_bf16 v[220:223], v[136:139], v[196:199], v[220:223]
    v_mfma_f32_16x16x32_bf16 v[224:227], v[140:143], v[196:199], v[224:227]
    v_mfma_f32_16x16x32_bf16 v[220:223], v[144:147], v[200:203], v[220:223]
    v_mfma_f32_16x16x32_bf16 v[224:227], v[148:151], v[200:203], v[224:227]
    v_mfma_f32_16x16x32_bf16 v[220:223], v[152:155], v[204:207], v[220:223]
    v_mfma_f32_16x16x32_bf16 v[224:227], v[156:159], v[204:207], v[224:227]
    v_mfma_f32_16x16x32_bf16 v[220:223], v[160:163], v[208:211], v[220:223]
    v_mfma_f32_16x16x32_bf16 v[224:227], v[164:167], v[208:211], v[224:227]
    v_mfma_f32_16x16x32_bf16 v[220:223], v[168:171], v[212:215], v[220:223]
    v_mfma_f32_16x16x32_bf16 v[224:227], v[172:175], v[212:215], v[224:227]
    v_mfma_f32_16x16x32_bf16 v[220:223], v[176:179], v[216:219], v[220:223]
    v_mfma_f32_16x16x32_bf16 v[224:227], v[180:183], v[216:219], v[224:227]
    v_add_u32 v6, 48, v3
    v_lshlrev_b32 v6, 2, v6
    s_nop 7
    ds_bpermute_b32 v7, v6, v224
    s_waitcnt lgkmcnt(0)
    v_rcp_f32 v7, v7
    s_nop 0
    v_mul_f32 v220, v220, v7
    v_mul_f32 v221, v221, v7
    v_mul_f32 v222, v222, v7
    v_mul_f32 v223, v223, v7
    v_mul_f32 v224, v224, v7
    v_mul_f32 v225, v225, v7
    v_mul_f32 v226, v226, v7
    v_mul_f32 v227, v227, v7
    v_cvt_pk_bf16_f32 v16, v220, v221
    v_cvt_pk_bf16_f32 v17, v222, v223
    v_cvt_pk_bf16_f32 v18, v224, v225
    v_cvt_pk_bf16_f32 v19, v226, v227
    s_lshl_b32 s33, s23, 4
    s_add_u32 s33, s33, s20
    s_lshl_b32 s33, s33, 10
    buffer_store_dwordx4 v[16:19], v5, s[48:51], s33 offen
qa_kernel_done:
    s_endpgm
.globl ffn_kernel
.p2align 8
.type ffn_kernel,@function
ffn_kernel:
    s_cmp_ge_u32 s2, 224
    s_cbranch_scc1 ffn_kernel_done
    s_load_dwordx4 s[4:7], s[0:1], 64
    s_load_dwordx2 s[46:47], s[0:1], 56
    v_lshrrev_b32 v1, 6, v0
    v_and_b32 v0, 63, v0
    s_nop 0
    v_readfirstlane_b32 s3, v1
    v_lshrrev_b32 v2, 4, v0
    v_and_b32 v3, 15, v0
    v_lshlrev_b32 v5, 4, v0
    v_add_u32 v6, 0xe000, v5
    s_and_b32 s28, s2, 7
    s_lshr_b32 s29, s2, 3
    s_mul_i32 s30, s29, 9363
    s_lshr_b32 s30, s30, 16
    s_mul_i32 s31, s30, 7
    s_sub_u32 s31, s29, s31
    s_lshr_b32 s20, s28, 1
    s_lshl_b32 s20, s20, 2
    s_add_u32 s20, s20, s30
    s_and_b32 s32, s28, 1
    s_mul_i32 s21, s32, 7
    s_add_u32 s21, s21, s31
    s_lshl_b32 s33, s20, 1
    s_add_u32 s33, s33, s32
    s_mul_i32 s34, s33, 57344
    s_lshl_b32 s35, s31, 11
    s_add_u32 s34, s34, s35
    s_lshl_b32 s35, s3, 9
    s_add_u32 s34, s34, s35
    v_lshrrev_b32 v7, 1, v2
    v_lshl_add_u32 v7, v7, 4, v3
    v_lshlrev_b32 v7, 4, v7
    v_and_b32 v8, 1, v2
    v_lshl_add_u32 v7, v8, 3, v7
    s_lshl_b32 s36, s3, 12
    s_lshl_b32 s37, s33, 16
    s_add_u32 s37, s37, s36
    s_lshl_b32 s38, s31, 16
    s_add_u32 s38, s38, s36
    s_add_u32 s38, s38, 0x200000
    s_mul_i32 s22, s20, 114688
    s_mul_i32 s23, s3, 28672
    s_add_u32 s22, s22, s23
    s_lshl_b32 s24, s3, 11
    s_lshl_b32 s25, s21, 2
    s_add_u32 s25, s25, s3
    s_lshl_b32 s26, s25, 8
    s_add_u32 s26, s26, 0x904000
    s_mul_i32 s25, s25, 57344
    s_add_u32 s25, s25, 0x300000
    s_mul_i32 s39, s3, 14336
    s_mul_i32 s40, s33, 229376
    s_add_u32 s40, s40, s39
    s_mul_i32 s41, s31, 229376
    s_add_u32 s41, s41, s39
    s_add_u32 s41, s41, 0x700000
    v_add_u32 v9, s24, v5
    v_add_u32 v10, 0xe000, v9
    s_lshl_b32 s42, s20, 8
    s_waitcnt lgkmcnt(0)
    s_add_u32 s8, s6, 0x1200000
    s_addc_u32 s9, s7, 0
    s_mov_b32 s10, 0x1c0000
    s_mov_b32 s11, 0x20000
    s_mov_b32 s12, s6
    s_mov_b32 s13, s7
    s_mov_b32 s14, 0x1000000
    s_mov_b32 s15, 0x20000
    s_add_u32 s16, s6, 0x1600000
    s_addc_u32 s17, s7, 0
    s_mov_b32 s18, 0x700000
    s_mov_b32 s19, 0x20000
    s_add_u32 s48, s6, 0x1000000
    s_addc_u32 s49, s7, 0
    s_mov_b32 s50, 0x200000
    s_mov_b32 s51, 0x20000
    s_add_u32 s80, s6, 0x1e00000
    s_addc_u32 s81, s7, 0
    s_mov_b32 s82, 0x1c0000
    s_mov_b32 s83, 0x20000
    s_add_u32 s84, s6, 0x9f0000
    s_addc_u32 s85, s7, 0
    s_mov_b32 s86, 0x2000
    s_mov_b32 s87, 0x20000
    s_mov_b32 s88, s46
    s_mov_b32 s89, s47
    s_mov_b32 s90, 0x1c0000
    s_mov_b32 s91, 0x20000
    s_or_b32 s28, s2, s3
    s_cmp_lg_u32 s28, 0
    s_cbranch_scc1 ffn_kernel_z1
    v_lshlrev_b32 v12, 6, v0
    v_mov_b32 v13, 0
    s_mov_b32 s28, 0x9e0000
    buffer_store_dword v13, v12, s[12:15], s28 offen
    s_mov_b32 s28, 0x9e1000
    buffer_store_dword v13, v12, s[12:15], s28 offen
    s_mov_b32 s28, 0x9e2000
    buffer_store_dword v13, v12, s[12:15], s28 offen
    s_mov_b32 s28, 0x9e3000
    buffer_store_dword v13, v12, s[12:15], s28 offen
ffn_kernel_z1:
    s_add_u32 s28, s37, 0
    buffer_load_dwordx4 v[128:131], v5, s[48:51], s28 offen offset:0
    s_add_u32 s28, s37, 16384
    buffer_load_dwordx4 v[132:135], v5, s[48:51], s28 offen offset:0
    s_add_u32 s28, s37, 32768
    buffer_load_dwordx4 v[136:139], v5, s[48:51], s28 offen offset:0
    s_add_u32 s28, s37, 49152
    buffer_load_dwordx4 v[140:143], v5, s[48:51], s28 offen offset:0
    s_add_u32 s28, s38, 0
    buffer_load_dwordx4 v[144:147], v5, s[12:15], s28 offen offset:0
    s_add_u32 s28, s38, 16384
    buffer_load_dwordx4 v[148:151], v5, s[12:15], s28 offen offset:0
    s_add_u32 s28, s38, 32768
    buffer_load_dwordx4 v[152:155], v5, s[12:15], s28 offen offset:0
    s_add_u32 s28, s38, 49152
    buffer_load_dwordx4 v[156:159], v5, s[12:15], s28 offen offset:0
    s_add_u32 s28, s37, 0
    buffer_load_dwordx4 v[160:163], v5, s[48:51], s28 offen offset:1024
    s_add_u32 s28, s37, 16384
    buffer_load_dwordx4 v[164:167], v5, s[48:51], s28 offen offset:1024
    s_add_u32 s28, s37, 32768
    buffer_load_dwordx4 v[168:171], v5, s[48:51], s28 offen offset:1024
    s_add_u32 s28, s37, 49152
    buffer_load_dwordx4 v[172:175], v5, s[48:51], s28 offen offset:1024
    s_add_u32 s28, s38, 0
    buffer_load_dwordx4 v[176:179], v5, s[12:15], s28 offen offset:1024
    s_add_u32 s28, s38, 16384
    buffer_load_dwordx4 v[180:183], v5, s[12:15], s28 offen offset:1024
    s_add_u32 s28, s38, 32768
    buffer_load_dwordx4 v[184:187], v5, s[12:15], s28 offen offset:1024
    s_add_u32 s28, s38, 49152
    buffer_load_dwordx4 v[188:191], v5, s[12:15], s28 offen offset:1024
    s_add_u32 s28, s37, 0
    buffer_load_dwordx4 v[192:195], v5, s[48:51], s28 offen offset:2048
    s_add_u32 s28, s37, 16384
    buffer_load_dwordx4 v[196:199], v5, s[48:51], s28 offen offset:2048
    s_add_u32 s28, s37, 32768
    buffer_load_dwordx4 v[200:203], v5, s[48:51], s28 offen offset:2048
    s_add_u32 s28, s37, 49152
    buffer_load_dwordx4 v[204:207], v5, s[48:51], s28 offen offset:2048
    s_add_u32 s28, s38, 0
    buffer_load_dwordx4 v[208:211], v5, s[12:15], s28 offen offset:2048
    s_add_u32 s28, s38, 16384
    buffer_load_dwordx4 v[212:215], v5, s[12:15], s28 offen offset:2048
    s_add_u32 s28, s38, 32768
    buffer_load_dwordx4 v[216:219], v5, s[12:15], s28 offen offset:2048
    s_add_u32 s28, s38, 49152
    buffer_load_dwordx4 v[220:223], v5, s[12:15], s28 offen offset:2048
    s_add_u32 s28, s37, 0
    buffer_load_dwordx4 v[224:227], v5, s[48:51], s28 offen offset:3072
    s_add_u32 s28, s37, 16384
    buffer_load_dwordx4 v[228:231], v5, s[48:51], s28 offen offset:3072
    s_add_u32 s28, s37, 32768
    buffer_load_dwordx4 v[232:235], v5, s[48:51], s28 offen offset:3072
    s_add_u32 s28, s37, 49152
    buffer_load_dwordx4 v[236:239], v5, s[48:51], s28 offen offset:3072
    s_add_u32 s28, s38, 0
    buffer_load_dwordx4 v[240:243], v5, s[12:15], s28 offen offset:3072
    s_add_u32 s28, s38, 16384
    buffer_load_dwordx4 v[244:247], v5, s[12:15], s28 offen offset:3072
    s_add_u32 s28, s38, 32768
    buffer_load_dwordx4 v[248:251], v5, s[12:15], s28 offen offset:3072
    s_add_u32 s28, s38, 49152
    buffer_load_dwordx4 v[252:255], v5, s[12:15], s28 offen offset:3072
    s_add_u32 s28, s34, 0
    buffer_load_dwordx2 v[116:117], v7, s[80:83], s28 offen
    s_add_u32 s28, s34, 14336
    buffer_load_dwordx2 v[118:119], v7, s[80:83], s28 offen
    s_add_u32 s28, s34, 28672
    buffer_load_dwordx2 v[120:121], v7, s[80:83], s28 offen
    s_add_u32 s28, s34, 43008
    buffer_load_dwordx2 v[122:123], v7, s[80:83], s28 offen
    s_add_u32 s28, s25, 0
    buffer_load_dwordx4 a[0:3], v5, s[12:15], s28 offen offset:0
    s_add_u32 s28, s25, 12288
    buffer_load_dwordx4 a[4:7], v5, s[12:15], s28 offen offset:2048
    s_add_u32 s28, s25, 28672
    buffer_load_dwordx4 a[8:11], v5, s[12:15], s28 offen offset:0
    s_add_u32 s28, s25, 40960
    buffer_load_dwordx4 a[12:15], v5, s[12:15], s28 offen offset:2048
    s_waitcnt vmcnt(32)
    v_mfma_f32_16x16x32_bf16 v[12:15], v[144:147], v[128:131], 0
    v_mfma_f32_16x16x32_bf16 v[16:19], v[144:147], v[132:135], 0
    v_mfma_f32_16x16x32_bf16 v[20:23], v[144:147], v[136:139], 0
    v_mfma_f32_16x16x32_bf16 v[24:27], v[144:147], v[140:143], 0
    v_mfma_f32_16x16x32_bf16 v[28:31], v[148:151], v[128:131], 0
    v_mfma_f32_16x16x32_bf16 v[32:35], v[148:151], v[132:135], 0
    v_mfma_f32_16x16x32_bf16 v[36:39], v[148:151], v[136:139], 0
    v_mfma_f32_16x16x32_bf16 v[40:43], v[148:151], v[140:143], 0
    v_mfma_f32_16x16x32_bf16 v[44:47], v[152:155], v[128:131], 0
    v_mfma_f32_16x16x32_bf16 v[48:51], v[152:155], v[132:135], 0
    v_mfma_f32_16x16x32_bf16 v[52:55], v[152:155], v[136:139], 0
    v_mfma_f32_16x16x32_bf16 v[56:59], v[152:155], v[140:143], 0
    v_mfma_f32_16x16x32_bf16 v[60:63], v[156:159], v[128:131], 0
    v_mfma_f32_16x16x32_bf16 v[64:67], v[156:159], v[132:135], 0
    v_mfma_f32_16x16x32_bf16 v[68:71], v[156:159], v[136:139], 0
    v_mfma_f32_16x16x32_bf16 v[72:75], v[156:159], v[140:143], 0
    s_waitcnt vmcnt(24)
    v_mfma_f32_16x16x32_bf16 v[12:15], v[176:179], v[160:163], v[12:15]
    v_mfma_f32_16x16x32_bf16 v[16:19], v[176:179], v[164:167], v[16:19]
    v_mfma_f32_16x16x32_bf16 v[20:23], v[176:179], v[168:171], v[20:23]
    v_mfma_f32_16x16x32_bf16 v[24:27], v[176:179], v[172:175], v[24:27]
    v_mfma_f32_16x16x32_bf16 v[28:31], v[180:183], v[160:163], v[28:31]
    v_mfma_f32_16x16x32_bf16 v[32:35], v[180:183], v[164:167], v[32:35]
    v_mfma_f32_16x16x32_bf16 v[36:39], v[180:183], v[168:171], v[36:39]
    v_mfma_f32_16x16x32_bf16 v[40:43], v[180:183], v[172:175], v[40:43]
    v_mfma_f32_16x16x32_bf16 v[44:47], v[184:187], v[160:163], v[44:47]
    v_mfma_f32_16x16x32_bf16 v[48:51], v[184:187], v[164:167], v[48:51]
    v_mfma_f32_16x16x32_bf16 v[52:55], v[184:187], v[168:171], v[52:55]
    v_mfma_f32_16x16x32_bf16 v[56:59], v[184:187], v[172:175], v[56:59]
    v_mfma_f32_16x16x32_bf16 v[60:63], v[188:191], v[160:163], v[60:63]
    v_mfma_f32_16x16x32_bf16 v[64:67], v[188:191], v[164:167], v[64:67]
    v_mfma_f32_16x16x32_bf16 v[68:71], v[188:191], v[168:171], v[68:71]
    v_mfma_f32_16x16x32_bf16 v[72:75], v[188:191], v[172:175], v[72:75]
    s_waitcnt vmcnt(16)
    v_mfma_f32_16x16x32_bf16 v[12:15], v[208:211], v[192:195], v[12:15]
    v_mfma_f32_16x16x32_bf16 v[16:19], v[208:211], v[196:199], v[16:19]
    v_mfma_f32_16x16x32_bf16 v[20:23], v[208:211], v[200:203], v[20:23]
    v_mfma_f32_16x16x32_bf16 v[24:27], v[208:211], v[204:207], v[24:27]
    v_mfma_f32_16x16x32_bf16 v[28:31], v[212:215], v[192:195], v[28:31]
    v_mfma_f32_16x16x32_bf16 v[32:35], v[212:215], v[196:199], v[32:35]
    v_mfma_f32_16x16x32_bf16 v[36:39], v[212:215], v[200:203], v[36:39]
    v_mfma_f32_16x16x32_bf16 v[40:43], v[212:215], v[204:207], v[40:43]
    v_mfma_f32_16x16x32_bf16 v[44:47], v[216:219], v[192:195], v[44:47]
    v_mfma_f32_16x16x32_bf16 v[48:51], v[216:219], v[196:199], v[48:51]
    v_mfma_f32_16x16x32_bf16 v[52:55], v[216:219], v[200:203], v[52:55]
    v_mfma_f32_16x16x32_bf16 v[56:59], v[216:219], v[204:207], v[56:59]
    v_mfma_f32_16x16x32_bf16 v[60:63], v[220:223], v[192:195], v[60:63]
    v_mfma_f32_16x16x32_bf16 v[64:67], v[220:223], v[196:199], v[64:67]
    v_mfma_f32_16x16x32_bf16 v[68:71], v[220:223], v[200:203], v[68:71]
    v_mfma_f32_16x16x32_bf16 v[72:75], v[220:223], v[204:207], v[72:75]
    s_waitcnt vmcnt(8)
    v_mfma_f32_16x16x32_bf16 v[12:15], v[240:243], v[224:227], v[12:15]
    v_mfma_f32_16x16x32_bf16 v[16:19], v[240:243], v[228:231], v[16:19]
    v_mfma_f32_16x16x32_bf16 v[20:23], v[240:243], v[232:235], v[20:23]
    v_mfma_f32_16x16x32_bf16 v[24:27], v[240:243], v[236:239], v[24:27]
    v_mfma_f32_16x16x32_bf16 v[28:31], v[244:247], v[224:227], v[28:31]
    v_mfma_f32_16x16x32_bf16 v[32:35], v[244:247], v[228:231], v[32:35]
    v_mfma_f32_16x16x32_bf16 v[36:39], v[244:247], v[232:235], v[36:39]
    v_mfma_f32_16x16x32_bf16 v[40:43], v[244:247], v[236:239], v[40:43]
    v_mfma_f32_16x16x32_bf16 v[44:47], v[248:251], v[224:227], v[44:47]
    v_mfma_f32_16x16x32_bf16 v[48:51], v[248:251], v[228:231], v[48:51]
    v_mfma_f32_16x16x32_bf16 v[52:55], v[248:251], v[232:235], v[52:55]
    v_mfma_f32_16x16x32_bf16 v[56:59], v[248:251], v[236:239], v[56:59]
    v_mfma_f32_16x16x32_bf16 v[60:63], v[252:255], v[224:227], v[60:63]
    v_mfma_f32_16x16x32_bf16 v[64:67], v[252:255], v[228:231], v[64:67]
    v_mfma_f32_16x16x32_bf16 v[68:71], v[252:255], v[232:235], v[68:71]
    v_mfma_f32_16x16x32_bf16 v[72:75], v[252:255], v[236:239], v[72:75]
    s_lshl_b32 s30, s3, 14
    v_add_u32 v11, s30, v5
    s_lshl_b32 s30, s3, 12
    v_add_u32 v4, s30, v5
    s_cmp_eq_u32 s3, 1
    s_cbranch_scc1 ffn_kernel_xw3
    s_cmp_eq_u32 s3, 2
    s_cbranch_scc1 ffn_kernel_xw4
    s_cmp_eq_u32 s3, 3
    s_cbranch_scc1 ffn_kernel_xw5
    s_nop 7
    ds_write_b128 v11, v[28:31] offset:4096
    ds_write_b128 v11, v[32:35] offset:5120
    ds_write_b128 v11, v[36:39] offset:6144
    ds_write_b128 v11, v[40:43] offset:7168
    ds_write_b128 v11, v[44:47] offset:8192
    ds_write_b128 v11, v[48:51] offset:9216
    ds_write_b128 v11, v[52:55] offset:10240
    ds_write_b128 v11, v[56:59] offset:11264
    ds_write_b128 v11, v[60:63] offset:12288
    ds_write_b128 v11, v[64:67] offset:13312
    ds_write_b128 v11, v[68:71] offset:14336
    ds_write_b128 v11, v[72:75] offset:15360
    s_waitcnt lgkmcnt(0)
    s_barrier
    ds_read_b128 v[128:131], v4 offset:16384
    ds_read_b128 v[132:135], v4 offset:32768
    ds_read_b128 v[136:139], v4 offset:49152
    ds_read_b128 v[140:143], v4 offset:17408
    ds_read_b128 v[144:147], v4 offset:33792
    ds_read_b128 v[148:151], v4 offset:50176
    ds_read_b128 v[152:155], v4 offset:18432
    ds_read_b128 v[156:159], v4 offset:34816
    ds_read_b128 v[160:163], v4 offset:51200
    ds_read_b128 v[164:167], v4 offset:19456
    ds_read_b128 v[168:171], v4 offset:35840
    ds_read_b128 v[172:175], v4 offset:52224
    s_waitcnt lgkmcnt(9)
    v_pk_add_f32 v[128:129], v[128:129], v[132:133]
    v_pk_add_f32 v[136:137], v[136:137], v[12:13]
    v_pk_add_f32 v[128:129], v[128:129], v[136:137]
    v_pk_add_f32 v[130:131], v[130:131], v[134:135]
    v_pk_add_f32 v[138:139], v[138:139], v[14:15]
    v_pk_add_f32 v[130:131], v[130:131], v[138:139]
    s_waitcnt lgkmcnt(6)
    v_pk_add_f32 v[140:141], v[140:141], v[144:145]
    v_pk_add_f32 v[148:149], v[148:149], v[16:17]
    v_pk_add_f32 v[140:141], v[140:141], v[148:149]
    v_pk_add_f32 v[142:143], v[142:143], v[146:147]
    v_pk_add_f32 v[150:151], v[150:151], v[18:19]
    v_pk_add_f32 v[142:143], v[142:143], v[150:151]
    s_waitcnt lgkmcnt(3)
    v_pk_add_f32 v[152:153], v[152:153], v[156:157]
    v_pk_add_f32 v[160:161], v[160:161], v[20:21]
    v_pk_add_f32 v[152:153], v[152:153], v[160:161]
    v_pk_add_f32 v[154:155], v[154:155], v[158:159]
    v_pk_add_f32 v[162:163], v[162:163], v[22:23]
    v_pk_add_f32 v[154:155], v[154:155], v[162:163]
    s_waitcnt lgkmcnt(0)
    v_pk_add_f32 v[164:165], v[164:165], v[168:169]
    v_pk_add_f32 v[172:173], v[172:173], v[24:25]
    v_pk_add_f32 v[164:165], v[164:165], v[172:173]
    v_pk_add_f32 v[166:167], v[166:167], v[170:171]
    v_pk_add_f32 v[174:175], v[174:175], v[26:27]
    v_pk_add_f32 v[166:167], v[166:167], v[174:175]
    s_branch ffn_kernel_xw6
ffn_kernel_xw3:
    s_nop 7
    ds_write_b128 v11, v[12:15] offset:0
    ds_write_b128 v11, v[16:19] offset:1024
    ds_write_b128 v11, v[20:23] offset:2048
    ds_write_b128 v11, v[24:27] offset:3072
    ds_write_b128 v11, v[44:47] offset:8192
    ds_write_b128 v11, v[48:51] offset:9216
    ds_write_b128 v11, v[52:55] offset:10240
    ds_write_b128 v11, v[56:59] offset:11264
    ds_write_b128 v11, v[60:63] offset:12288
    ds_write_b128 v11, v[64:67] offset:13312
    ds_write_b128 v11, v[68:71] offset:14336
    ds_write_b128 v11, v[72:75] offset:15360
    s_waitcnt lgkmcnt(0)
    s_barrier
    ds_read_b128 v[128:131], v4 offset:0
    ds_read_b128 v[132:135], v4 offset:32768
    ds_read_b128 v[136:139], v4 offset:49152
    ds_read_b128 v[140:143], v4 offset:1024
    ds_read_b128 v[144:147], v4 offset:33792
    ds_read_b128 v[148:151], v4 offset:50176
    ds_read_b128 v[152:155], v4 offset:2048
    ds_read_b128 v[156:159], v4 offset:34816
    ds_read_b128 v[160:163], v4 offset:51200
    ds_read_b128 v[164:167], v4 offset:3072
    ds_read_b128 v[168:171], v4 offset:35840
    ds_read_b128 v[172:175], v4 offset:52224
    s_waitcnt lgkmcnt(9)
    v_pk_add_f32 v[128:129], v[128:129], v[132:133]
    v_pk_add_f32 v[136:137], v[136:137], v[28:29]
    v_pk_add_f32 v[128:129], v[128:129], v[136:137]
    v_pk_add_f32 v[130:131], v[130:131], v[134:135]
    v_pk_add_f32 v[138:139], v[138:139], v[30:31]
    v_pk_add_f32 v[130:131], v[130:131], v[138:139]
    s_waitcnt lgkmcnt(6)
    v_pk_add_f32 v[140:141], v[140:141], v[144:145]
    v_pk_add_f32 v[148:149], v[148:149], v[32:33]
    v_pk_add_f32 v[140:141], v[140:141], v[148:149]
    v_pk_add_f32 v[142:143], v[142:143], v[146:147]
    v_pk_add_f32 v[150:151], v[150:151], v[34:35]
    v_pk_add_f32 v[142:143], v[142:143], v[150:151]
    s_waitcnt lgkmcnt(3)
    v_pk_add_f32 v[152:153], v[152:153], v[156:157]
    v_pk_add_f32 v[160:161], v[160:161], v[36:37]
    v_pk_add_f32 v[152:153], v[152:153], v[160:161]
    v_pk_add_f32 v[154:155], v[154:155], v[158:159]
    v_pk_add_f32 v[162:163], v[162:163], v[38:39]
    v_pk_add_f32 v[154:155], v[154:155], v[162:163]
    s_waitcnt lgkmcnt(0)
    v_pk_add_f32 v[164:165], v[164:165], v[168:169]
    v_pk_add_f32 v[172:173], v[172:173], v[40:41]
    v_pk_add_f32 v[164:165], v[164:165], v[172:173]
    v_pk_add_f32 v[166:167], v[166:167], v[170:171]
    v_pk_add_f32 v[174:175], v[174:175], v[42:43]
    v_pk_add_f32 v[166:167], v[166:167], v[174:175]
    s_branch ffn_kernel_xw6
ffn_kernel_xw4:
    s_nop 7
    ds_write_b128 v11, v[12:15] offset:0
    ds_write_b128 v11, v[16:19] offset:1024
    ds_write_b128 v11, v[20:23] offset:2048
    ds_write_b128 v11, v[24:27] offset:3072
    ds_write_b128 v11, v[28:31] offset:4096
    ds_write_b128 v11, v[32:35] offset:5120
    ds_write_b128 v11, v[36:39] offset:6144
    ds_write_b128 v11, v[40:43] offset:7168
    ds_write_b128 v11, v[60:63] offset:12288
    ds_write_b128 v11, v[64:67] offset:13312
    ds_write_b128 v11, v[68:71] offset:14336
    ds_write_b128 v11, v[72:75] offset:15360
    s_waitcnt lgkmcnt(0)
    s_barrier
    ds_read_b128 v[128:131], v4 offset:0
    ds_read_b128 v[132:135], v4 offset:16384
    ds_read_b128 v[136:139], v4 offset:49152
    ds_read_b128 v[140:143], v4 offset:1024
    ds_read_b128 v[144:147], v4 offset:17408
    ds_read_b128 v[148:151], v4 offset:50176
    ds_read_b128 v[152:155], v4 offset:2048
    ds_read_b128 v[156:159], v4 offset:18432
    ds_read_b128 v[160:163], v4 offset:51200
    ds_read_b128 v[164:167], v4 offset:3072
    ds_read_b128 v[168:171], v4 offset:19456
    ds_read_b128 v[172:175], v4 offset:52224
    s_waitcnt lgkmcnt(9)
    v_pk_add_f32 v[128:129], v[128:129], v[132:133]
    v_pk_add_f32 v[136:137], v[136:137], v[44:45]
    v_pk_add_f32 v[128:129], v[128:129], v[136:137]
    v_pk_add_f32 v[130:131], v[130:131], v[134:135]
    v_pk_add_f32 v[138:139], v[138:139], v[46:47]
    v_pk_add_f32 v[130:131], v[130:131], v[138:139]
    s_waitcnt lgkmcnt(6)
    v_pk_add_f32 v[140:141], v[140:141], v[144:145]
    v_pk_add_f32 v[148:149], v[148:149], v[48:49]
    v_pk_add_f32 v[140:141], v[140:141], v[148:149]
    v_pk_add_f32 v[142:143], v[142:143], v[146:147]
    v_pk_add_f32 v[150:151], v[150:151], v[50:51]
    v_pk_add_f32 v[142:143], v[142:143], v[150:151]
    s_waitcnt lgkmcnt(3)
    v_pk_add_f32 v[152:153], v[152:153], v[156:157]
    v_pk_add_f32 v[160:161], v[160:161], v[52:53]
    v_pk_add_f32 v[152:153], v[152:153], v[160:161]
    v_pk_add_f32 v[154:155], v[154:155], v[158:159]
    v_pk_add_f32 v[162:163], v[162:163], v[54:55]
    v_pk_add_f32 v[154:155], v[154:155], v[162:163]
    s_waitcnt lgkmcnt(0)
    v_pk_add_f32 v[164:165], v[164:165], v[168:169]
    v_pk_add_f32 v[172:173], v[172:173], v[56:57]
    v_pk_add_f32 v[164:165], v[164:165], v[172:173]
    v_pk_add_f32 v[166:167], v[166:167], v[170:171]
    v_pk_add_f32 v[174:175], v[174:175], v[58:59]
    v_pk_add_f32 v[166:167], v[166:167], v[174:175]
    s_branch ffn_kernel_xw6
ffn_kernel_xw5:
    s_nop 7
    ds_write_b128 v11, v[12:15] offset:0
    ds_write_b128 v11, v[16:19] offset:1024
    ds_write_b128 v11, v[20:23] offset:2048
    ds_write_b128 v11, v[24:27] offset:3072
    ds_write_b128 v11, v[28:31] offset:4096
    ds_write_b128 v11, v[32:35] offset:5120
    ds_write_b128 v11, v[36:39] offset:6144
    ds_write_b128 v11, v[40:43] offset:7168
    ds_write_b128 v11, v[44:47] offset:8192
    ds_write_b128 v11, v[48:51] offset:9216
    ds_write_b128 v11, v[52:55] offset:10240
    ds_write_b128 v11, v[56:59] offset:11264
    s_waitcnt lgkmcnt(0)
    s_barrier
    ds_read_b128 v[128:131], v4 offset:0
    ds_read_b128 v[132:135], v4 offset:16384
    ds_read_b128 v[136:139], v4 offset:32768
    ds_read_b128 v[140:143], v4 offset:1024
    ds_read_b128 v[144:147], v4 offset:17408
    ds_read_b128 v[148:151], v4 offset:33792
    ds_read_b128 v[152:155], v4 offset:2048
    ds_read_b128 v[156:159], v4 offset:18432
    ds_read_b128 v[160:163], v4 offset:34816
    ds_read_b128 v[164:167], v4 offset:3072
    ds_read_b128 v[168:171], v4 offset:19456
    ds_read_b128 v[172:175], v4 offset:35840
    s_waitcnt lgkmcnt(9)
    v_pk_add_f32 v[128:129], v[128:129], v[132:133]
    v_pk_add_f32 v[136:137], v[136:137], v[60:61]
    v_pk_add_f32 v[128:129], v[128:129], v[136:137]
    v_pk_add_f32 v[130:131], v[130:131], v[134:135]
    v_pk_add_f32 v[138:139], v[138:139], v[62:63]
    v_pk_add_f32 v[130:131], v[130:131], v[138:139]
    s_waitcnt lgkmcnt(6)
    v_pk_add_f32 v[140:141], v[140:141], v[144:145]
    v_pk_add_f32 v[148:149], v[148:149], v[64:65]
    v_pk_add_f32 v[140:141], v[140:141], v[148:149]
    v_pk_add_f32 v[142:143], v[142:143], v[146:147]
    v_pk_add_f32 v[150:151], v[150:151], v[66:67]
    v_pk_add_f32 v[142:143], v[142:143], v[150:151]
    s_waitcnt lgkmcnt(3)
    v_pk_add_f32 v[152:153], v[152:153], v[156:157]
    v_pk_add_f32 v[160:161], v[160:161], v[68:69]
    v_pk_add_f32 v[152:153], v[152:153], v[160:161]
    v_pk_add_f32 v[154:155], v[154:155], v[158:159]
    v_pk_add_f32 v[162:163], v[162:163], v[70:71]
    v_pk_add_f32 v[154:155], v[154:155], v[162:163]
    s_waitcnt lgkmcnt(0)
    v_pk_add_f32 v[164:165], v[164:165], v[168:169]
    v_pk_add_f32 v[172:173], v[172:173], v[72:73]
    v_pk_add_f32 v[164:165], v[164:165], v[172:173]
    v_pk_add_f32 v[166:167], v[166:167], v[170:171]
    v_pk_add_f32 v[174:175], v[174:175], v[74:75]
    v_pk_add_f32 v[166:167], v[166:167], v[174:175]
ffn_kernel_xw6:
    s_barrier
    s_waitcnt vmcnt(4)
    v_cvt_pk_bf16_f32 v136, v128, v129
    v_cvt_pk_bf16_f32 v137, v130, v131
    v_lshlrev_b32 v128, 16, v136
    v_and_b32 v129, 0xffff0000, v136
    v_lshlrev_b32 v132, 16, v116
    v_and_b32 v133, 0xffff0000, v116
    v_pk_add_f32 v[128:129], v[128:129], v[132:133]
    v_cvt_pk_bf16_f32 v136, v128, v129
    v_lshlrev_b32 v130, 16, v137
    v_and_b32 v131, 0xffff0000, v137
    v_lshlrev_b32 v134, 16, v117
    v_and_b32 v135, 0xffff0000, v117
    v_pk_add_f32 v[130:131], v[130:131], v[134:135]
    v_cvt_pk_bf16_f32 v137, v130, v131
    s_add_u32 s28, s34, 0
    buffer_store_dwordx2 v[136:137], v7, s[8:11], s28 offen sc0 sc1
    v_accvgpr_write_b32 a224, v136
    v_accvgpr_write_b32 a225, v137
    v_cvt_pk_bf16_f32 v148, v140, v141
    v_cvt_pk_bf16_f32 v149, v142, v143
    v_lshlrev_b32 v140, 16, v148
    v_and_b32 v141, 0xffff0000, v148
    v_lshlrev_b32 v144, 16, v118
    v_and_b32 v145, 0xffff0000, v118
    v_pk_add_f32 v[140:141], v[140:141], v[144:145]
    v_cvt_pk_bf16_f32 v148, v140, v141
    v_lshlrev_b32 v142, 16, v149
    v_and_b32 v143, 0xffff0000, v149
    v_lshlrev_b32 v146, 16, v119
    v_and_b32 v147, 0xffff0000, v119
    v_pk_add_f32 v[142:143], v[142:143], v[146:147]
    v_cvt_pk_bf16_f32 v149, v142, v143
    s_add_u32 s28, s34, 14336
    buffer_store_dwordx2 v[148:149], v7, s[8:11], s28 offen sc0 sc1
    v_accvgpr_write_b32 a226, v148
    v_accvgpr_write_b32 a227, v149
    v_cvt_pk_bf16_f32 v160, v152, v153
    v_cvt_pk_bf16_f32 v161, v154, v155
    v_lshlrev_b32 v152, 16, v160
    v_and_b32 v153, 0xffff0000, v160
    v_lshlrev_b32 v156, 16, v120
    v_and_b32 v157, 0xffff0000, v120
    v_pk_add_f32 v[152:153], v[152:153], v[156:157]
    v_cvt_pk_bf16_f32 v160, v152, v153
    v_lshlrev_b32 v154, 16, v161
    v_and_b32 v155, 0xffff0000, v161
    v_lshlrev_b32 v158, 16, v121
    v_and_b32 v159, 0xffff0000, v121
    v_pk_add_f32 v[154:155], v[154:155], v[158:159]
    v_cvt_pk_bf16_f32 v161, v154, v155
    s_add_u32 s28, s34, 28672
    buffer_store_dwordx2 v[160:161], v7, s[8:11], s28 offen sc0 sc1
    v_accvgpr_write_b32 a228, v160
    v_accvgpr_write_b32 a229, v161
    v_cvt_pk_bf16_f32 v172, v164, v165
    v_cvt_pk_bf16_f32 v173, v166, v167
    v_lshlrev_b32 v164, 16, v172
    v_and_b32 v165, 0xffff0000, v172
    v_lshlrev_b32 v168, 16, v122
    v_and_b32 v169, 0xffff0000, v122
    v_pk_add_f32 v[164:165], v[164:165], v[168:169]
    v_cvt_pk_bf16_f32 v172, v164, v165
    v_lshlrev_b32 v166, 16, v173
    v_and_b32 v167, 0xffff0000, v173
    v_lshlrev_b32 v170, 16, v123
    v_and_b32 v171, 0xffff0000, v123
    v_pk_add_f32 v[166:167], v[166:167], v[170:171]
    v_cvt_pk_bf16_f32 v173, v166, v167
    s_add_u32 s28, s34, 43008
    buffer_store_dwordx2 v[172:173], v7, s[8:11], s28 offen sc0 sc1
    v_accvgpr_write_b32 a230, v172
    v_accvgpr_write_b32 a231, v173
    s_waitcnt vmcnt(0)
    s_barrier
    s_cmp_lg_u32 s3, 0
    s_cbranch_scc1 ffn_kernel_s17
    s_add_u32 s28, s42, 0
    v_mov_b32 v11, s28
    v_mov_b32 v4, 1
    s_mov_b64 s[44:45], exec
    s_mov_b64 exec, 1
    buffer_atomic_add v4, v11, s[84:87], 0 offen sc1
    s_mov_b32 s29, 0
ffn_kernel_s18:
    buffer_load_dword v4, v11, s[84:87], 0 offen sc0 sc1
    s_waitcnt vmcnt(0)
    v_readfirstlane_b32 s30, v4
    s_add_u32 s29, s29, 1
    s_cmp_ge_u32 s30, 14
    s_cbranch_scc1 ffn_kernel_s19
    s_cmp_ge_u32 s29, 0x40000
    s_cbranch_scc1 ffn_kernel_s19
    s_sleep 1
    s_branch ffn_kernel_s18
ffn_kernel_s19:
    s_mov_b64 exec, s[44:45]
ffn_kernel_s17:
    s_add_u32 s28, s25, 0
    buffer_load_dwordx4 a[16:19], v5, s[12:15], s28 offen offset:1024
    s_add_u32 s28, s25, 12288
    buffer_load_dwordx4 a[20:23], v5, s[12:15], s28 offen offset:3072
    s_add_u32 s28, s25, 28672
    buffer_load_dwordx4 a[24:27], v5, s[12:15], s28 offen offset:1024
    s_add_u32 s28, s25, 40960
    buffer_load_dwordx4 a[28:31], v5, s[12:15], s28 offen offset:3072
    s_add_u32 s28, s25, 0
    buffer_load_dwordx4 a[32:35], v5, s[12:15], s28 offen offset:2048
    s_add_u32 s28, s25, 16384
    buffer_load_dwordx4 a[36:39], v5, s[12:15], s28 offen offset:0
    s_add_u32 s28, s25, 28672
    buffer_load_dwordx4 a[40:43], v5, s[12:15], s28 offen offset:2048
    s_add_u32 s28, s25, 45056
    buffer_load_dwordx4 a[44:47], v5, s[12:15], s28 offen offset:0
    s_add_u32 s28, s25, 0
    buffer_load_dwordx4 a[48:51], v5, s[12:15], s28 offen offset:3072
    s_add_u32 s28, s25, 16384
    buffer_load_dwordx4 a[52:55], v5, s[12:15], s28 offen offset:1024
    s_add_u32 s28, s25, 28672
    buffer_load_dwordx4 a[56:59], v5, s[12:15], s28 offen offset:3072
    s_add_u32 s28, s25, 45056
    buffer_load_dwordx4 a[60:63], v5, s[12:15], s28 offen offset:1024
    s_add_u32 s28, s25, 4096
    buffer_load_dwordx4 a[64:67], v5, s[12:15], s28 offen offset:0
    s_add_u32 s28, s25, 16384
    buffer_load_dwordx4 a[68:71], v5, s[12:15], s28 offen offset:2048
    s_add_u32 s28, s25, 32768
    buffer_load_dwordx4 a[72:75], v5, s[12:15], s28 offen offset:0
    s_add_u32 s28, s25, 45056
    buffer_load_dwordx4 a[76:79], v5, s[12:15], s28 offen offset:2048
    s_add_u32 s28, s25, 4096
    buffer_load_dwordx4 a[80:83], v5, s[12:15], s28 offen offset:1024
    s_add_u32 s28, s25, 16384
    buffer_load_dwordx4 a[84:87], v5, s[12:15], s28 offen offset:3072
    s_add_u32 s28, s25, 32768
    buffer_load_dwordx4 a[88:91], v5, s[12:15], s28 offen offset:1024
    s_add_u32 s28, s25, 45056
    buffer_load_dwordx4 a[92:95], v5, s[12:15], s28 offen offset:3072
    s_add_u32 s28, s25, 4096
    buffer_load_dwordx4 a[96:99], v5, s[12:15], s28 offen offset:2048
    s_add_u32 s28, s25, 20480
    buffer_load_dwordx4 a[100:103], v5, s[12:15], s28 offen offset:0
    s_add_u32 s28, s25, 32768
    buffer_load_dwordx4 a[104:107], v5, s[12:15], s28 offen offset:2048
    s_add_u32 s28, s25, 49152
    buffer_load_dwordx4 a[108:111], v5, s[12:15], s28 offen offset:0
    s_add_u32 s28, s25, 4096
    buffer_load_dwordx4 a[112:115], v5, s[12:15], s28 offen offset:3072
    s_add_u32 s28, s25, 20480
    buffer_load_dwordx4 a[116:119], v5, s[12:15], s28 offen offset:1024
    s_add_u32 s28, s25, 32768
    buffer_load_dwordx4 a[120:123], v5, s[12:15], s28 offen offset:3072
    s_add_u32 s28, s25, 49152
    buffer_load_dwordx4 a[124:127], v5, s[12:15], s28 offen offset:1024
    s_add_u32 s28, s25, 8192
    buffer_load_dwordx4 a[128:131], v5, s[12:15], s28 offen offset:0
    s_add_u32 s28, s25, 20480
    buffer_load_dwordx4 a[132:135], v5, s[12:15], s28 offen offset:2048
    s_barrier
    v_lshlrev_b32 v4, 4, v2
    buffer_load_dwordx4 v[112:115], v4, s[12:15], s26 offen offset:0
    buffer_load_dwordx4 v[116:119], v4, s[12:15], s26 offen offset:64
    buffer_load_dwordx4 v[120:123], v4, s[12:15], s26 offen offset:128
    buffer_load_dwordx4 v[124:127], v4, s[12:15], s26 offen offset:192
    s_add_u32 m0, s24, 0
    s_add_u32 s27, s22, 0
    buffer_load_dwordx4 v5, s[8:11], s27 offen sc0 sc1 lds
    s_add_u32 m0, s24, 1024
    s_add_u32 s27, s22, 14336
    buffer_load_dwordx4 v5, s[8:11], s27 offen sc0 sc1 lds
    s_add_u32 m0, s24, 8192
    s_add_u32 s27, s22, 1024
    buffer_load_dwordx4 v5, s[8:11], s27 offen sc0 sc1 lds
    s_add_u32 m0, s24, 9216
    s_add_u32 s27, s22, 15360
    buffer_load_dwordx4 v5, s[8:11], s27 offen sc0 sc1 lds
    s_add_u32 m0, s24, 16384
    s_add_u32 s27, s22, 2048
    buffer_load_dwordx4 v5, s[8:11], s27 offen sc0 sc1 lds
    s_add_u32 m0, s24, 17408
    s_add_u32 s27, s22, 16384
    buffer_load_dwordx4 v5, s[8:11], s27 offen sc0 sc1 lds
    s_add_u32 m0, s24, 24576
    s_add_u32 s27, s22, 3072
    buffer_load_dwordx4 v5, s[8:11], s27 offen sc0 sc1 lds
    s_add_u32 m0, s24, 25600
    s_add_u32 s27, s22, 17408
    buffer_load_dwordx4 v5, s[8:11], s27 offen sc0 sc1 lds
    s_add_u32 m0, s24, 32768
    s_add_u32 s27, s22, 4096
    buffer_load_dwordx4 v5, s[8:11], s27 offen sc0 sc1 lds
    s_add_u32 m0, s24, 33792
    s_add_u32 s27, s22, 18432
    buffer_load_dwordx4 v5, s[8:11], s27 offen sc0 sc1 lds
    s_add_u32 m0, s24, 40960
    s_add_u32 s27, s22, 5120
    buffer_load_dwordx4 v5, s[8:11], s27 offen sc0 sc1 lds
    s_add_u32 m0, s24, 41984
    s_add_u32 s27, s22, 19456
    buffer_load_dwordx4 v5, s[8:11], s27 offen sc0 sc1 lds
    s_add_u32 m0, s24, 49152
    s_add_u32 s27, s22, 6144
    buffer_load_dwordx4 v5, s[8:11], s27 offen sc0 sc1 lds
    s_add_u32 m0, s24, 50176
    s_add_u32 s27, s22, 20480
    buffer_load_dwordx4 v5, s[8:11], s27 offen sc0 sc1 lds
    s_add_u32 m0, s24, 57344
    s_add_u32 s27, s22, 7168
    buffer_load_dwordx4 v5, s[8:11], s27 offen sc0 sc1 lds
    s_add_u32 m0, s24, 58368
    s_add_u32 s27, s22, 21504
    buffer_load_dwordx4 v5, s[8:11], s27 offen sc0 sc1 lds
    s_add_u32 m0, s24, 65536
    s_add_u32 s27, s22, 8192
    buffer_load_dwordx4 v5, s[8:11], s27 offen sc0 sc1 lds
    s_add_u32 m0, s24, 66560
    s_add_u32 s27, s22, 22528
    buffer_load_dwordx4 v5, s[8:11], s27 offen sc0 sc1 lds
    s_add_u32 m0, s24, 73728
    s_add_u32 s27, s22, 9216
    buffer_load_dwordx4 v5, s[8:11], s27 offen sc0 sc1 lds
    s_add_u32 m0, s24, 74752
    s_add_u32 s27, s22, 23552
    buffer_load_dwordx4 v5, s[8:11], s27 offen sc0 sc1 lds
    s_add_u32 m0, s24, 81920
    s_add_u32 s27, s22, 10240
    buffer_load_dwordx4 v5, s[8:11], s27 offen sc0 sc1 lds
    s_add_u32 m0, s24, 82944
    s_add_u32 s27, s22, 24576
    buffer_load_dwordx4 v5, s[8:11], s27 offen sc0 sc1 lds
    s_add_u32 m0, s24, 90112
    s_add_u32 s27, s22, 11264
    buffer_load_dwordx4 v5, s[8:11], s27 offen sc0 sc1 lds
    s_add_u32 m0, s24, 91136
    s_add_u32 s27, s22, 25600
    buffer_load_dwordx4 v5, s[8:11], s27 offen sc0 sc1 lds
    s_add_u32 m0, s24, 98304
    s_add_u32 s27, s22, 12288
    buffer_load_dwordx4 v5, s[8:11], s27 offen sc0 sc1 lds
    s_add_u32 m0, s24, 99328
    s_add_u32 s27, s22, 26624
    buffer_load_dwordx4 v5, s[8:11], s27 offen sc0 sc1 lds
    s_add_u32 m0, s24, 106496
    s_add_u32 s27, s22, 13312
    buffer_load_dwordx4 v5, s[8:11], s27 offen sc0 sc1 lds
    s_add_u32 m0, s24, 107520
    s_add_u32 s27, s22, 27648
    buffer_load_dwordx4 v5, s[8:11], s27 offen sc0 sc1 lds
    v_mov_b32 v108, 0x3f803f80
    v_mov_b32 v109, 0x3f803f80
    v_mov_b32 v110, 0x3f803f80
    v_mov_b32 v111, 0x3f803f80
    s_waitcnt vmcnt(24)
    s_barrier
    ds_read_b128 v[12:15], v5 offset:0
    ds_read_b128 v[16:19], v5 offset:1024
    ds_read_b128 v[20:23], v5 offset:2048
    ds_read_b128 v[24:27], v5 offset:3072
    ds_read_b128 v[28:31], v5 offset:4096
    ds_read_b128 v[32:35], v5 offset:5120
    ds_read_b128 v[36:39], v5 offset:6144
    ds_read_b128 v[40:43], v5 offset:7168
    ds_read_b128 v[76:79], v9 offset:0
    ds_read_b128 v[80:83], v9 offset:1024
    s_waitcnt vmcnt(20)
    s_barrier
    s_waitcnt lgkmcnt(0)
    ds_read_b128 v[44:47], v5 offset:8192
    ds_read_b128 v[48:51], v5 offset:9216
    ds_read_b128 v[52:55], v5 offset:10240
    ds_read_b128 v[56:59], v5 offset:11264
    ds_read_b128 v[60:63], v5 offset:12288
    ds_read_b128 v[64:67], v5 offset:13312
    ds_read_b128 v[68:71], v5 offset:14336
    ds_read_b128 v[72:75], v5 offset:15360
    ds_read_b128 v[84:87], v9 offset:8192
    ds_read_b128 v[88:91], v9 offset:9216
    v_mfma_f32_16x16x32_bf16 v[128:131], a[0:3], v[12:15], 0
    v_mfma_f32_16x16x32_bf16 v[132:135], a[4:7], v[12:15], 0
    v_mfma_f32_16x16x32_bf16 v[136:139], a[8:11], v[12:15], 0
    v_mfma_f32_16x16x32_bf16 v[140:143], a[12:15], v[12:15], 0
    v_mfma_f32_16x16x32_bf16 v[144:147], a[0:3], v[16:19], 0
    v_mfma_f32_16x16x32_bf16 v[148:151], a[4:7], v[16:19], 0
    v_mfma_f32_16x16x32_bf16 v[152:155], a[8:11], v[16:19], 0
    v_mfma_f32_16x16x32_bf16 v[156:159], a[12:15], v[16:19], 0
    v_mfma_f32_16x16x32_bf16 v[160:163], a[0:3], v[20:23], 0
    v_mfma_f32_16x16x32_bf16 v[164:167], a[4:7], v[20:23], 0
    v_mfma_f32_16x16x32_bf16 v[168:171], a[8:11], v[20:23], 0
    v_mfma_f32_16x16x32_bf16 v[172:175], a[12:15], v[20:23], 0
    v_mfma_f32_16x16x32_bf16 v[176:179], a[0:3], v[24:27], 0
    v_mfma_f32_16x16x32_bf16 v[180:183], a[4:7], v[24:27], 0
    v_mfma_f32_16x16x32_bf16 v[184:187], a[8:11], v[24:27], 0
    v_mfma_f32_16x16x32_bf16 v[188:191], a[12:15], v[24:27], 0
    v_mfma_f32_16x16x32_bf16 v[192:195], a[0:3], v[28:31], 0
    v_mfma_f32_16x16x32_bf16 v[196:199], a[4:7], v[28:31], 0
    v_mfma_f32_16x16x32_bf16 v[200:203], a[8:11], v[28:31], 0
    v_mfma_f32_16x16x32_bf16 v[204:207], a[12:15], v[28:31], 0
    v_mfma_f32_16x16x32_bf16 v[208:211], a[0:3], v[32:35], 0
    v_mfma_f32_16x16x32_bf16 v[212:215], a[4:7], v[32:35], 0
    v_mfma_f32_16x16x32_bf16 v[216:219], a[8:11], v[32:35], 0
    v_mfma_f32_16x16x32_bf16 v[220:223], a[12:15], v[32:35], 0
    v_mfma_f32_16x16x32_bf16 v[224:227], a[0:3], v[36:39], 0
    v_mfma_f32_16x16x32_bf16 v[228:231], a[4:7], v[36:39], 0
    v_mfma_f32_16x16x32_bf16 v[232:235], a[8:11], v[36:39], 0
    v_mfma_f32_16x16x32_bf16 v[236:239], a[12:15], v[36:39], 0
    v_mfma_f32_16x16x32_bf16 v[240:243], a[0:3], v[40:43], 0
    v_mfma_f32_16x16x32_bf16 v[244:247], a[4:7], v[40:43], 0
    v_mfma_f32_16x16x32_bf16 v[248:251], a[8:11], v[40:43], 0
    v_mfma_f32_16x16x32_bf16 v[252:255], a[12:15], v[40:43], 0
    v_mfma_f32_16x16x32_bf16 v[92:95], v[108:111], v[76:79], 0
    v_mfma_f32_16x16x32_bf16 v[96:99], v[76:79], v[76:79], 0
    v_mfma_f32_16x16x32_bf16 v[100:103], v[108:111], v[80:83], 0
    v_mfma_f32_16x16x32_bf16 v[104:107], v[80:83], v[80:83], 0
    s_waitcnt lgkmcnt(0)
    ds_read_b128 v[12:15], v5 offset:16384
    ds_read_b128 v[16:19], v5 offset:17408
    ds_read_b128 v[20:23], v5 offset:18432
    ds_read_b128 v[24:27], v5 offset:19456
    ds_read_b128 v[28:31], v5 offset:20480
    ds_read_b128 v[32:35], v5 offset:21504
    ds_read_b128 v[36:39], v5 offset:22528
    ds_read_b128 v[40:43], v5 offset:23552
    ds_read_b128 v[76:79], v9 offset:16384
    ds_read_b128 v[80:83], v9 offset:17408
    v_mfma_f32_16x16x32_bf16 v[128:131], a[16:19], v[44:47], v[128:131]
    v_mfma_f32_16x16x32_bf16 v[132:135], a[20:23], v[44:47], v[132:135]
    v_mfma_f32_16x16x32_bf16 v[136:139], a[24:27], v[44:47], v[136:139]
    v_mfma_f32_16x16x32_bf16 v[140:143], a[28:31], v[44:47], v[140:143]
    s_add_u32 s28, s25, 36864
    buffer_load_dwordx4 a[136:139], v5, s[12:15], s28 offen offset:0
    v_mfma_f32_16x16x32_bf16 v[144:147], a[16:19], v[48:51], v[144:147]
    v_mfma_f32_16x16x32_bf16 v[148:151], a[20:23], v[48:51], v[148:151]
    v_mfma_f32_16x16x32_bf16 v[152:155], a[24:27], v[48:51], v[152:155]
    v_mfma_f32_16x16x32_bf16 v[156:159], a[28:31], v[48:51], v[156:159]
    s_add_u32 s28, s25, 49152
    buffer_load_dwordx4 a[140:143], v5, s[12:15], s28 offen offset:2048
    s_add_u32 s28, s41, 0
    buffer_load_dwordx4 a[0:3], v5, s[12:15], s28 offen offset:0
    v_mfma_f32_16x16x32_bf16 v[160:163], a[16:19], v[52:55], v[160:163]
    v_mfma_f32_16x16x32_bf16 v[164:167], a[20:23], v[52:55], v[164:167]
    v_mfma_f32_16x16x32_bf16 v[168:171], a[24:27], v[52:55], v[168:171]
    v_mfma_f32_16x16x32_bf16 v[172:175], a[28:31], v[52:55], v[172:175]
    s_add_u32 s28, s25, 8192
    buffer_load_dwordx4 a[144:147], v5, s[12:15], s28 offen offset:1024
    v_mfma_f32_16x16x32_bf16 v[176:179], a[16:19], v[56:59], v[176:179]
    v_mfma_f32_16x16x32_bf16 v[180:183], a[20:23], v[56:59], v[180:183]
    v_mfma_f32_16x16x32_bf16 v[184:187], a[24:27], v[56:59], v[184:187]
    v_mfma_f32_16x16x32_bf16 v[188:191], a[28:31], v[56:59], v[188:191]
    s_add_u32 s28, s25, 20480
    buffer_load_dwordx4 a[148:151], v5, s[12:15], s28 offen offset:3072
    s_add_u32 s28, s41, 57344
    buffer_load_dwordx4 a[4:7], v5, s[12:15], s28 offen offset:0
    v_mfma_f32_16x16x32_bf16 v[192:195], a[16:19], v[60:63], v[192:195]
    v_mfma_f32_16x16x32_bf16 v[196:199], a[20:23], v[60:63], v[196:199]
    v_mfma_f32_16x16x32_bf16 v[200:203], a[24:27], v[60:63], v[200:203]
    v_mfma_f32_16x16x32_bf16 v[204:207], a[28:31], v[60:63], v[204:207]
    s_add_u32 s28, s25, 36864
    buffer_load_dwordx4 a[152:155], v5, s[12:15], s28 offen offset:1024
    v_mfma_f32_16x16x32_bf16 v[208:211], a[16:19], v[64:67], v[208:211]
    v_mfma_f32_16x16x32_bf16 v[212:215], a[20:23], v[64:67], v[212:215]
    v_mfma_f32_16x16x32_bf16 v[216:219], a[24:27], v[64:67], v[216:219]
    v_mfma_f32_16x16x32_bf16 v[220:223], a[28:31], v[64:67], v[220:223]
    s_add_u32 s28, s25, 49152
    buffer_load_dwordx4 a[156:159], v5, s[12:15], s28 offen offset:3072
    s_add_u32 s28, s41, 114688
    buffer_load_dwordx4 a[8:11], v5, s[12:15], s28 offen offset:0
    v_mfma_f32_16x16x32_bf16 v[224:227], a[16:19], v[68:71], v[224:227]
    v_mfma_f32_16x16x32_bf16 v[228:231], a[20:23], v[68:71], v[228:231]
    v_mfma_f32_16x16x32_bf16 v[232:235], a[24:27], v[68:71], v[232:235]
    v_mfma_f32_16x16x32_bf16 v[236:239], a[28:31], v[68:71], v[236:239]
    s_add_u32 s28, s25, 8192
    buffer_load_dwordx4 a[160:163], v5, s[12:15], s28 offen offset:2048
    v_mfma_f32_16x16x32_bf16 v[240:243], a[16:19], v[72:75], v[240:243]
    v_mfma_f32_16x16x32_bf16 v[244:247], a[20:23], v[72:75], v[244:247]
    v_mfma_f32_16x16x32_bf16 v[248:251], a[24:27], v[72:75], v[248:251]
    v_mfma_f32_16x16x32_bf16 v[252:255], a[28:31], v[72:75], v[252:255]
    s_add_u32 s28, s25, 24576
    buffer_load_dwordx4 a[164:167], v5, s[12:15], s28 offen offset:0
    s_add_u32 s28, s41, 172032
    buffer_load_dwordx4 a[12:15], v5, s[12:15], s28 offen offset:0
    v_mfma_f32_16x16x32_bf16 v[92:95], v[108:111], v[84:87], v[92:95]
    v_mfma_f32_16x16x32_bf16 v[96:99], v[84:87], v[84:87], v[96:99]
    v_mfma_f32_16x16x32_bf16 v[100:103], v[108:111], v[88:91], v[100:103]
    v_mfma_f32_16x16x32_bf16 v[104:107], v[88:91], v[88:91], v[104:107]
    s_waitcnt vmcnt(26)
    s_barrier
    s_waitcnt lgkmcnt(0)
    ds_read_b128 v[44:47], v5 offset:24576
    ds_read_b128 v[48:51], v5 offset:25600
    ds_read_b128 v[52:55], v5 offset:26624
    ds_read_b128 v[56:59], v5 offset:27648
    ds_read_b128 v[60:63], v5 offset:28672
    ds_read_b128 v[64:67], v5 offset:29696
    ds_read_b128 v[68:71], v5 offset:30720
    ds_read_b128 v[72:75], v5 offset:31744
    ds_read_b128 v[84:87], v9 offset:24576
    ds_read_b128 v[88:91], v9 offset:25600
    v_mfma_f32_16x16x32_bf16 v[128:131], a[32:35], v[12:15], v[128:131]
    v_mfma_f32_16x16x32_bf16 v[132:135], a[36:39], v[12:15], v[132:135]
    v_mfma_f32_16x16x32_bf16 v[136:139], a[40:43], v[12:15], v[136:139]
    v_mfma_f32_16x16x32_bf16 v[140:143], a[44:47], v[12:15], v[140:143]
    s_add_u32 s28, s25, 36864
    buffer_load_dwordx4 a[168:171], v5, s[12:15], s28 offen offset:2048
    v_mfma_f32_16x16x32_bf16 v[144:147], a[32:35], v[16:19], v[144:147]
    v_mfma_f32_16x16x32_bf16 v[148:151], a[36:39], v[16:19], v[148:151]
    v_mfma_f32_16x16x32_bf16 v[152:155], a[40:43], v[16:19], v[152:155]
    v_mfma_f32_16x16x32_bf16 v[156:159], a[44:47], v[16:19], v[156:159]
    s_add_u32 s28, s25, 53248
    buffer_load_dwordx4 a[172:175], v5, s[12:15], s28 offen offset:0
    s_add_u32 s28, s41, 0
    buffer_load_dwordx4 a[16:19], v5, s[12:15], s28 offen offset:1024
    v_mfma_f32_16x16x32_bf16 v[160:163], a[32:35], v[20:23], v[160:163]
    v_mfma_f32_16x16x32_bf16 v[164:167], a[36:39], v[20:23], v[164:167]
    v_mfma_f32_16x16x32_bf16 v[168:171], a[40:43], v[20:23], v[168:171]
    v_mfma_f32_16x16x32_bf16 v[172:175], a[44:47], v[20:23], v[172:175]
    s_add_u32 s28, s25, 8192
    buffer_load_dwordx4 a[176:179], v5, s[12:15], s28 offen offset:3072
    v_mfma_f32_16x16x32_bf16 v[176:179], a[32:35], v[24:27], v[176:179]
    v_mfma_f32_16x16x32_bf16 v[180:183], a[36:39], v[24:27], v[180:183]
    v_mfma_f32_16x16x32_bf16 v[184:187], a[40:43], v[24:27], v[184:187]
    v_mfma_f32_16x16x32_bf16 v[188:191], a[44:47], v[24:27], v[188:191]
    s_add_u32 s28, s25, 24576
    buffer_load_dwordx4 a[180:183], v5, s[12:15], s28 offen offset:1024
    s_add_u32 s28, s41, 57344
    buffer_load_dwordx4 a[20:23], v5, s[12:15], s28 offen offset:1024
    v_mfma_f32_16x16x32_bf16 v[192:195], a[32:35], v[28:31], v[192:195]
    v_mfma_f32_16x16x32_bf16 v[196:199], a[36:39], v[28:31], v[196:199]
    v_mfma_f32_16x16x32_bf16 v[200:203], a[40:43], v[28:31], v[200:203]
    v_mfma_f32_16x16x32_bf16 v[204:207], a[44:47], v[28:31], v[204:207]
    s_add_u32 s28, s25, 36864
    buffer_load_dwordx4 a[184:187], v5, s[12:15], s28 offen offset:3072
    v_mfma_f32_16x16x32_bf16 v[208:211], a[32:35], v[32:35], v[208:211]
    v_mfma_f32_16x16x32_bf16 v[212:215], a[36:39], v[32:35], v[212:215]
    v_mfma_f32_16x16x32_bf16 v[216:219], a[40:43], v[32:35], v[216:219]
    v_mfma_f32_16x16x32_bf16 v[220:223], a[44:47], v[32:35], v[220:223]
    s_add_u32 s28, s25, 53248
    buffer_load_dwordx4 a[188:191], v5, s[12:15], s28 offen offset:1024
    s_add_u32 s28, s41, 114688
    buffer_load_dwordx4 a[24:27], v5, s[12:15], s28 offen offset:1024
    v_mfma_f32_16x16x32_bf16 v[224:227], a[32:35], v[36:39], v[224:227]
    v_mfma_f32_16x16x32_bf16 v[228:231], a[36:39], v[36:39], v[228:231]
    v_mfma_f32_16x16x32_bf16 v[232:235], a[40:43], v[36:39], v[232:235]
    v_mfma_f32_16x16x32_bf16 v[236:239], a[44:47], v[36:39], v[236:239]
    s_add_u32 s28, s25, 12288
    buffer_load_dwordx4 a[192:195], v5, s[12:15], s28 offen offset:0
    v_mfma_f32_16x16x32_bf16 v[240:243], a[32:35], v[40:43], v[240:243]
    v_mfma_f32_16x16x32_bf16 v[244:247], a[36:39], v[40:43], v[244:247]
    v_mfma_f32_16x16x32_bf16 v[248:251], a[40:43], v[40:43], v[248:251]
    v_mfma_f32_16x16x32_bf16 v[252:255], a[44:47], v[40:43], v[252:255]
    s_add_u32 s28, s25, 24576
    buffer_load_dwordx4 a[196:199], v5, s[12:15], s28 offen offset:2048
    s_add_u32 s28, s41, 172032
    buffer_load_dwordx4 a[28:31], v5, s[12:15], s28 offen offset:1024
    v_mfma_f32_16x16x32_bf16 v[92:95], v[108:111], v[76:79], v[92:95]
    v_mfma_f32_16x16x32_bf16 v[96:99], v[76:79], v[76:79], v[96:99]
    v_mfma_f32_16x16x32_bf16 v[100:103], v[108:111], v[80:83], v[100:103]
    v_mfma_f32_16x16x32_bf16 v[104:107], v[80:83], v[80:83], v[104:107]
    s_waitcnt lgkmcnt(0)
    ds_read_b128 v[12:15], v5 offset:32768
    ds_read_b128 v[16:19], v5 offset:33792
    ds_read_b128 v[20:23], v5 offset:34816
    ds_read_b128 v[24:27], v5 offset:35840
    ds_read_b128 v[28:31], v5 offset:36864
    ds_read_b128 v[32:35], v5 offset:37888
    ds_read_b128 v[36:39], v5 offset:38912
    ds_read_b128 v[40:43], v5 offset:39936
    ds_read_b128 v[76:79], v9 offset:32768
    ds_read_b128 v[80:83], v9 offset:33792
    v_mfma_f32_16x16x32_bf16 v[128:131], a[48:51], v[44:47], v[128:131]
    v_mfma_f32_16x16x32_bf16 v[132:135], a[52:55], v[44:47], v[132:135]
    v_mfma_f32_16x16x32_bf16 v[136:139], a[56:59], v[44:47], v[136:139]
    v_mfma_f32_16x16x32_bf16 v[140:143], a[60:63], v[44:47], v[140:143]
    s_add_u32 s28, s25, 40960
    buffer_load_dwordx4 a[200:203], v5, s[12:15], s28 offen offset:0
    v_mfma_f32_16x16x32_bf16 v[144:147], a[48:51], v[48:51], v[144:147]
    v_mfma_f32_16x16x32_bf16 v[148:151], a[52:55], v[48:51], v[148:151]
    v_mfma_f32_16x16x32_bf16 v[152:155], a[56:59], v[48:51], v[152:155]
    v_mfma_f32_16x16x32_bf16 v[156:159], a[60:63], v[48:51], v[156:159]
    s_add_u32 s28, s25, 53248
    buffer_load_dwordx4 a[204:207], v5, s[12:15], s28 offen offset:2048
    s_add_u32 s28, s41, 0
    buffer_load_dwordx4 a[32:35], v5, s[12:15], s28 offen offset:2048
    v_mfma_f32_16x16x32_bf16 v[160:163], a[48:51], v[52:55], v[160:163]
    v_mfma_f32_16x16x32_bf16 v[164:167], a[52:55], v[52:55], v[164:167]
    v_mfma_f32_16x16x32_bf16 v[168:171], a[56:59], v[52:55], v[168:171]
    v_mfma_f32_16x16x32_bf16 v[172:175], a[60:63], v[52:55], v[172:175]
    s_add_u32 s28, s25, 12288
    buffer_load_dwordx4 a[208:211], v5, s[12:15], s28 offen offset:1024
    v_mfma_f32_16x16x32_bf16 v[176:179], a[48:51], v[56:59], v[176:179]
    v_mfma_f32_16x16x32_bf16 v[180:183], a[52:55], v[56:59], v[180:183]
    v_mfma_f32_16x16x32_bf16 v[184:187], a[56:59], v[56:59], v[184:187]
    v_mfma_f32_16x16x32_bf16 v[188:191], a[60:63], v[56:59], v[188:191]
    s_add_u32 s28, s25, 24576
    buffer_load_dwordx4 a[212:215], v5, s[12:15], s28 offen offset:3072
    s_add_u32 s28, s41, 57344
    buffer_load_dwordx4 a[36:39], v5, s[12:15], s28 offen offset:2048
    v_mfma_f32_16x16x32_bf16 v[192:195], a[48:51], v[60:63], v[192:195]
    v_mfma_f32_16x16x32_bf16 v[196:199], a[52:55], v[60:63], v[196:199]
    v_mfma_f32_16x16x32_bf16 v[200:203], a[56:59], v[60:63], v[200:203]
    v_mfma_f32_16x16x32_bf16 v[204:207], a[60:63], v[60:63], v[204:207]
    s_add_u32 s28, s25, 40960
    buffer_load_dwordx4 a[216:219], v5, s[12:15], s28 offen offset:1024
    v_mfma_f32_16x16x32_bf16 v[208:211], a[48:51], v[64:67], v[208:211]
    v_mfma_f32_16x16x32_bf16 v[212:215], a[52:55], v[64:67], v[212:215]
    v_mfma_f32_16x16x32_bf16 v[216:219], a[56:59], v[64:67], v[216:219]
    v_mfma_f32_16x16x32_bf16 v[220:223], a[60:63], v[64:67], v[220:223]
    s_add_u32 s28, s25, 53248
    buffer_load_dwordx4 a[220:223], v5, s[12:15], s28 offen offset:3072
    s_add_u32 s28, s41, 114688
    buffer_load_dwordx4 a[40:43], v5, s[12:15], s28 offen offset:2048
    v_mfma_f32_16x16x32_bf16 v[224:227], a[48:51], v[68:71], v[224:227]
    v_mfma_f32_16x16x32_bf16 v[228:231], a[52:55], v[68:71], v[228:231]
    v_mfma_f32_16x16x32_bf16 v[232:235], a[56:59], v[68:71], v[232:235]
    v_mfma_f32_16x16x32_bf16 v[236:239], a[60:63], v[68:71], v[236:239]
    v_mfma_f32_16x16x32_bf16 v[240:243], a[48:51], v[72:75], v[240:243]
    v_mfma_f32_16x16x32_bf16 v[244:247], a[52:55], v[72:75], v[244:247]
    v_mfma_f32_16x16x32_bf16 v[248:251], a[56:59], v[72:75], v[248:251]
    v_mfma_f32_16x16x32_bf16 v[252:255], a[60:63], v[72:75], v[252:255]
    s_add_u32 s28, s41, 172032
    buffer_load_dwordx4 a[44:47], v5, s[12:15], s28 offen offset:2048
    v_mfma_f32_16x16x32_bf16 v[92:95], v[108:111], v[84:87], v[92:95]
    v_mfma_f32_16x16x32_bf16 v[96:99], v[84:87], v[84:87], v[96:99]
    v_mfma_f32_16x16x32_bf16 v[100:103], v[108:111], v[88:91], v[100:103]
    v_mfma_f32_16x16x32_bf16 v[104:107], v[88:91], v[88:91], v[104:107]
    s_waitcnt lgkmcnt(0)
    ds_read_b128 v[44:47], v5 offset:40960
    ds_read_b128 v[48:51], v5 offset:41984
    ds_read_b128 v[52:55], v5 offset:43008
    ds_read_b128 v[56:59], v5 offset:44032
    ds_read_b128 v[60:63], v5 offset:45056
    ds_read_b128 v[64:67], v5 offset:46080
    ds_read_b128 v[68:71], v5 offset:47104
    ds_read_b128 v[72:75], v5 offset:48128
    ds_read_b128 v[84:87], v9 offset:40960
    ds_read_b128 v[88:91], v9 offset:41984
    v_mfma_f32_16x16x32_bf16 v[128:131], a[64:67], v[12:15], v[128:131]
    v_mfma_f32_16x16x32_bf16 v[132:135], a[68:71], v[12:15], v[132:135]
    v_mfma_f32_16x16x32_bf16 v[136:139], a[72:75], v[12:15], v[136:139]
    v_mfma_f32_16x16x32_bf16 v[140:143], a[76:79], v[12:15], v[140:143]
    v_mfma_f32_16x16x32_bf16 v[144:147], a[64:67], v[16:19], v[144:147]
    v_mfma_f32_16x16x32_bf16 v[148:151], a[68:71], v[16:19], v[148:151]
    v_mfma_f32_16x16x32_bf16 v[152:155], a[72:75], v[16:19], v[152:155]
    v_mfma_f32_16x16x32_bf16 v[156:159], a[76:79], v[16:19], v[156:159]
    s_add_u32 s28, s41, 0
    buffer_load_dwordx4 a[48:51], v5, s[12:15], s28 offen offset:3072
    v_mfma_f32_16x16x32_bf16 v[160:163], a[64:67], v[20:23], v[160:163]
    v_mfma_f32_16x16x32_bf16 v[164:167], a[68:71], v[20:23], v[164:167]
    v_mfma_f32_16x16x32_bf16 v[168:171], a[72:75], v[20:23], v[168:171]
    v_mfma_f32_16x16x32_bf16 v[172:175], a[76:79], v[20:23], v[172:175]
    v_mfma_f32_16x16x32_bf16 v[176:179], a[64:67], v[24:27], v[176:179]
    v_mfma_f32_16x16x32_bf16 v[180:183], a[68:71], v[24:27], v[180:183]
    v_mfma_f32_16x16x32_bf16 v[184:187], a[72:75], v[24:27], v[184:187]
    v_mfma_f32_16x16x32_bf16 v[188:191], a[76:79], v[24:27], v[188:191]
    s_add_u32 s28, s41, 57344
    buffer_load_dwordx4 a[52:55], v5, s[12:15], s28 offen offset:3072
    v_mfma_f32_16x16x32_bf16 v[192:195], a[64:67], v[28:31], v[192:195]
    v_mfma_f32_16x16x32_bf16 v[196:199], a[68:71], v[28:31], v[196:199]
    v_mfma_f32_16x16x32_bf16 v[200:203], a[72:75], v[28:31], v[200:203]
    v_mfma_f32_16x16x32_bf16 v[204:207], a[76:79], v[28:31], v[204:207]
    v_mfma_f32_16x16x32_bf16 v[208:211], a[64:67], v[32:35], v[208:211]
    v_mfma_f32_16x16x32_bf16 v[212:215], a[68:71], v[32:35], v[212:215]
    v_mfma_f32_16x16x32_bf16 v[216:219], a[72:75], v[32:35], v[216:219]
    v_mfma_f32_16x16x32_bf16 v[220:223], a[76:79], v[32:35], v[220:223]
    s_add_u32 s28, s41, 114688
    buffer_load_dwordx4 a[56:59], v5, s[12:15], s28 offen offset:3072
    v_mfma_f32_16x16x32_bf16 v[224:227], a[64:67], v[36:39], v[224:227]
    v_mfma_f32_16x16x32_bf16 v[228:231], a[68:71], v[36:39], v[228:231]
    v_mfma_f32_16x16x32_bf16 v[232:235], a[72:75], v[36:39], v[232:235]
    v_mfma_f32_16x16x32_bf16 v[236:239], a[76:79], v[36:39], v[236:239]
    v_mfma_f32_16x16x32_bf16 v[240:243], a[64:67], v[40:43], v[240:243]
    v_mfma_f32_16x16x32_bf16 v[244:247], a[68:71], v[40:43], v[244:247]
    v_mfma_f32_16x16x32_bf16 v[248:251], a[72:75], v[40:43], v[248:251]
    v_mfma_f32_16x16x32_bf16 v[252:255], a[76:79], v[40:43], v[252:255]
    s_add_u32 s28, s41, 172032
    buffer_load_dwordx4 a[60:63], v5, s[12:15], s28 offen offset:3072
    v_mfma_f32_16x16x32_bf16 v[92:95], v[108:111], v[76:79], v[92:95]
    v_mfma_f32_16x16x32_bf16 v[96:99], v[76:79], v[76:79], v[96:99]
    v_mfma_f32_16x16x32_bf16 v[100:103], v[108:111], v[80:83], v[100:103]
    v_mfma_f32_16x16x32_bf16 v[104:107], v[80:83], v[80:83], v[104:107]
    s_waitcnt vmcnt(46)
    s_barrier
    s_waitcnt lgkmcnt(0)
    ds_read_b128 v[12:15], v5 offset:49152
    ds_read_b128 v[16:19], v5 offset:50176
    ds_read_b128 v[20:23], v5 offset:51200
    ds_read_b128 v[24:27], v5 offset:52224
    ds_read_b128 v[28:31], v5 offset:53248
    ds_read_b128 v[32:35], v5 offset:54272
    ds_read_b128 v[36:39], v5 offset:55296
    ds_read_b128 v[40:43], v5 offset:56320
    ds_read_b128 v[76:79], v9 offset:49152
    ds_read_b128 v[80:83], v9 offset:50176
    v_mfma_f32_16x16x32_bf16 v[128:131], a[80:83], v[44:47], v[128:131]
    v_mfma_f32_16x16x32_bf16 v[132:135], a[84:87], v[44:47], v[132:135]
    v_mfma_f32_16x16x32_bf16 v[136:139], a[88:91], v[44:47], v[136:139]
    v_mfma_f32_16x16x32_bf16 v[140:143], a[92:95], v[44:47], v[140:143]
    v_mfma_f32_16x16x32_bf16 v[144:147], a[80:83], v[48:51], v[144:147]
    v_mfma_f32_16x16x32_bf16 v[148:151], a[84:87], v[48:51], v[148:151]
    v_mfma_f32_16x16x32_bf16 v[152:155], a[88:91], v[48:51], v[152:155]
    v_mfma_f32_16x16x32_bf16 v[156:159], a[92:95], v[48:51], v[156:159]
    s_add_u32 s28, s41, 4096
    buffer_load_dwordx4 a[64:67], v5, s[12:15], s28 offen offset:0
    v_mfma_f32_16x16x32_bf16 v[160:163], a[80:83], v[52:55], v[160:163]
    v_mfma_f32_16x16x32_bf16 v[164:167], a[84:87], v[52:55], v[164:167]
    v_mfma_f32_16x16x32_bf16 v[168:171], a[88:91], v[52:55], v[168:171]
    v_mfma_f32_16x16x32_bf16 v[172:175], a[92:95], v[52:55], v[172:175]
    v_mfma_f32_16x16x32_bf16 v[176:179], a[80:83], v[56:59], v[176:179]
    v_mfma_f32_16x16x32_bf16 v[180:183], a[84:87], v[56:59], v[180:183]
    v_mfma_f32_16x16x32_bf16 v[184:187], a[88:91], v[56:59], v[184:187]
    v_mfma_f32_16x16x32_bf16 v[188:191], a[92:95], v[56:59], v[188:191]
    s_add_u32 s28, s41, 61440
    buffer_load_dwordx4 a[68:71], v5, s[12:15], s28 offen offset:0
    v_mfma_f32_16x16x32_bf16 v[192:195], a[80:83], v[60:63], v[192:195]
    v_mfma_f32_16x16x32_bf16 v[196:199], a[84:87], v[60:63], v[196:199]
    v_mfma_f32_16x16x32_bf16 v[200:203], a[88:91], v[60:63], v[200:203]
    v_mfma_f32_16x16x32_bf16 v[204:207], a[92:95], v[60:63], v[204:207]
    v_mfma_f32_16x16x32_bf16 v[208:211], a[80:83], v[64:67], v[208:211]
    v_mfma_f32_16x16x32_bf16 v[212:215], a[84:87], v[64:67], v[212:215]
    v_mfma_f32_16x16x32_bf16 v[216:219], a[88:91], v[64:67], v[216:219]
    v_mfma_f32_16x16x32_bf16 v[220:223], a[92:95], v[64:67], v[220:223]
    s_add_u32 s28, s41, 118784
    buffer_load_dwordx4 a[72:75], v5, s[12:15], s28 offen offset:0
    v_mfma_f32_16x16x32_bf16 v[224:227], a[80:83], v[68:71], v[224:227]
    v_mfma_f32_16x16x32_bf16 v[228:231], a[84:87], v[68:71], v[228:231]
    v_mfma_f32_16x16x32_bf16 v[232:235], a[88:91], v[68:71], v[232:235]
    v_mfma_f32_16x16x32_bf16 v[236:239], a[92:95], v[68:71], v[236:239]
    v_mfma_f32_16x16x32_bf16 v[240:243], a[80:83], v[72:75], v[240:243]
    v_mfma_f32_16x16x32_bf16 v[244:247], a[84:87], v[72:75], v[244:247]
    v_mfma_f32_16x16x32_bf16 v[248:251], a[88:91], v[72:75], v[248:251]
    v_mfma_f32_16x16x32_bf16 v[252:255], a[92:95], v[72:75], v[252:255]
    s_add_u32 s28, s41, 176128
    buffer_load_dwordx4 a[76:79], v5, s[12:15], s28 offen offset:0
    v_mfma_f32_16x16x32_bf16 v[92:95], v[108:111], v[84:87], v[92:95]
    v_mfma_f32_16x16x32_bf16 v[96:99], v[84:87], v[84:87], v[96:99]
    v_mfma_f32_16x16x32_bf16 v[100:103], v[108:111], v[88:91], v[100:103]
    v_mfma_f32_16x16x32_bf16 v[104:107], v[88:91], v[88:91], v[104:107]
    s_waitcnt lgkmcnt(0)
    ds_read_b128 v[44:47], v6 offset:0
    ds_read_b128 v[48:51], v6 offset:1024
    ds_read_b128 v[52:55], v6 offset:2048
    ds_read_b128 v[56:59], v6 offset:3072
    ds_read_b128 v[60:63], v6 offset:4096
    ds_read_b128 v[64:67], v6 offset:5120
    ds_read_b128 v[68:71], v6 offset:6144
    ds_read_b128 v[72:75], v6 offset:7168
    ds_read_b128 v[84:87], v10 offset:0
    ds_read_b128 v[88:91], v10 offset:1024
    v_mfma_f32_16x16x32_bf16 v[128:131], a[96:99], v[12:15], v[128:131]
    v_mfma_f32_16x16x32_bf16 v[132:135], a[100:103], v[12:15], v[132:135]
    v_mfma_f32_16x16x32_bf16 v[136:139], a[104:107], v[12:15], v[136:139]
    v_mfma_f32_16x16x32_bf16 v[140:143], a[108:111], v[12:15], v[140:143]
    v_mfma_f32_16x16x32_bf16 v[144:147], a[96:99], v[16:19], v[144:147]
    v_mfma_f32_16x16x32_bf16 v[148:151], a[100:103], v[16:19], v[148:151]
    v_mfma_f32_16x16x32_bf16 v[152:155], a[104:107], v[16:19], v[152:155]
    v_mfma_f32_16x16x32_bf16 v[156:159], a[108:111], v[16:19], v[156:159]
    s_add_u32 s28, s41, 4096
    buffer_load_dwordx4 a[80:83], v5, s[12:15], s28 offen offset:1024
    v_mfma_f32_16x16x32_bf16 v[160:163], a[96:99], v[20:23], v[160:163]
    v_mfma_f32_16x16x32_bf16 v[164:167], a[100:103], v[20:23], v[164:167]
    v_mfma_f32_16x16x32_bf16 v[168:171], a[104:107], v[20:23], v[168:171]
    v_mfma_f32_16x16x32_bf16 v[172:175], a[108:111], v[20:23], v[172:175]
    v_mfma_f32_16x16x32_bf16 v[176:179], a[96:99], v[24:27], v[176:179]
    v_mfma_f32_16x16x32_bf16 v[180:183], a[100:103], v[24:27], v[180:183]
    v_mfma_f32_16x16x32_bf16 v[184:187], a[104:107], v[24:27], v[184:187]
    v_mfma_f32_16x16x32_bf16 v[188:191], a[108:111], v[24:27], v[188:191]
    s_add_u32 s28, s41, 61440
    buffer_load_dwordx4 a[84:87], v5, s[12:15], s28 offen offset:1024
    v_mfma_f32_16x16x32_bf16 v[192:195], a[96:99], v[28:31], v[192:195]
    v_mfma_f32_16x16x32_bf16 v[196:199], a[100:103], v[28:31], v[196:199]
    v_mfma_f32_16x16x32_bf16 v[200:203], a[104:107], v[28:31], v[200:203]
    v_mfma_f32_16x16x32_bf16 v[204:207], a[108:111], v[28:31], v[204:207]
    v_mfma_f32_16x16x32_bf16 v[208:211], a[96:99], v[32:35], v[208:211]
    v_mfma_f32_16x16x32_bf16 v[212:215], a[100:103], v[32:35], v[212:215]
    v_mfma_f32_16x16x32_bf16 v[216:219], a[104:107], v[32:35], v[216:219]
    v_mfma_f32_16x16x32_bf16 v[220:223], a[108:111], v[32:35], v[220:223]
    s_add_u32 s28, s41, 118784
    buffer_load_dwordx4 a[88:91], v5, s[12:15], s28 offen offset:1024
    v_mfma_f32_16x16x32_bf16 v[224:227], a[96:99], v[36:39], v[224:227]
    v_mfma_f32_16x16x32_bf16 v[228:231], a[100:103], v[36:39], v[228:231]
    v_mfma_f32_16x16x32_bf16 v[232:235], a[104:107], v[36:39], v[232:235]
    v_mfma_f32_16x16x32_bf16 v[236:239], a[108:111], v[36:39], v[236:239]
    v_mfma_f32_16x16x32_bf16 v[240:243], a[96:99], v[40:43], v[240:243]
    v_mfma_f32_16x16x32_bf16 v[244:247], a[100:103], v[40:43], v[244:247]
    v_mfma_f32_16x16x32_bf16 v[248:251], a[104:107], v[40:43], v[248:251]
    v_mfma_f32_16x16x32_bf16 v[252:255], a[108:111], v[40:43], v[252:255]
    s_add_u32 s28, s41, 176128
    buffer_load_dwordx4 a[92:95], v5, s[12:15], s28 offen offset:1024
    v_mfma_f32_16x16x32_bf16 v[92:95], v[108:111], v[76:79], v[92:95]
    v_mfma_f32_16x16x32_bf16 v[96:99], v[76:79], v[76:79], v[96:99]
    v_mfma_f32_16x16x32_bf16 v[100:103], v[108:111], v[80:83], v[100:103]
    v_mfma_f32_16x16x32_bf16 v[104:107], v[80:83], v[80:83], v[104:107]
    s_waitcnt lgkmcnt(0)
    ds_read_b128 v[12:15], v6 offset:8192
    ds_read_b128 v[16:19], v6 offset:9216
    ds_read_b128 v[20:23], v6 offset:10240
    ds_read_b128 v[24:27], v6 offset:11264
    ds_read_b128 v[28:31], v6 offset:12288
    ds_read_b128 v[32:35], v6 offset:13312
    ds_read_b128 v[36:39], v6 offset:14336
    ds_read_b128 v[40:43], v6 offset:15360
    ds_read_b128 v[76:79], v10 offset:8192
    ds_read_b128 v[80:83], v10 offset:9216
    v_mfma_f32_16x16x32_bf16 v[128:131], a[112:115], v[44:47], v[128:131]
    v_mfma_f32_16x16x32_bf16 v[132:135], a[116:119], v[44:47], v[132:135]
    v_mfma_f32_16x16x32_bf16 v[136:139], a[120:123], v[44:47], v[136:139]
    v_mfma_f32_16x16x32_bf16 v[140:143], a[124:127], v[44:47], v[140:143]
    v_mfma_f32_16x16x32_bf16 v[144:147], a[112:115], v[48:51], v[144:147]
    v_mfma_f32_16x16x32_bf16 v[148:151], a[116:119], v[48:51], v[148:151]
    v_mfma_f32_16x16x32_bf16 v[152:155], a[120:123], v[48:51], v[152:155]
    v_mfma_f32_16x16x32_bf16 v[156:159], a[124:127], v[48:51], v[156:159]
    s_add_u32 s28, s41, 4096
    buffer_load_dwordx4 a[96:99], v5, s[12:15], s28 offen offset:2048
    v_mfma_f32_16x16x32_bf16 v[160:163], a[112:115], v[52:55], v[160:163]
    v_mfma_f32_16x16x32_bf16 v[164:167], a[116:119], v[52:55], v[164:167]
    v_mfma_f32_16x16x32_bf16 v[168:171], a[120:123], v[52:55], v[168:171]
    v_mfma_f32_16x16x32_bf16 v[172:175], a[124:127], v[52:55], v[172:175]
    v_mfma_f32_16x16x32_bf16 v[176:179], a[112:115], v[56:59], v[176:179]
    v_mfma_f32_16x16x32_bf16 v[180:183], a[116:119], v[56:59], v[180:183]
    v_mfma_f32_16x16x32_bf16 v[184:187], a[120:123], v[56:59], v[184:187]
    v_mfma_f32_16x16x32_bf16 v[188:191], a[124:127], v[56:59], v[188:191]
    s_add_u32 s28, s41, 61440
    buffer_load_dwordx4 a[100:103], v5, s[12:15], s28 offen offset:2048
    v_mfma_f32_16x16x32_bf16 v[192:195], a[112:115], v[60:63], v[192:195]
    v_mfma_f32_16x16x32_bf16 v[196:199], a[116:119], v[60:63], v[196:199]
    v_mfma_f32_16x16x32_bf16 v[200:203], a[120:123], v[60:63], v[200:203]
    v_mfma_f32_16x16x32_bf16 v[204:207], a[124:127], v[60:63], v[204:207]
    v_mfma_f32_16x16x32_bf16 v[208:211], a[112:115], v[64:67], v[208:211]
    v_mfma_f32_16x16x32_bf16 v[212:215], a[116:119], v[64:67], v[212:215]
    v_mfma_f32_16x16x32_bf16 v[216:219], a[120:123], v[64:67], v[216:219]
    v_mfma_f32_16x16x32_bf16 v[220:223], a[124:127], v[64:67], v[220:223]
    s_add_u32 s28, s41, 118784
    buffer_load_dwordx4 a[104:107], v5, s[12:15], s28 offen offset:2048
    v_mfma_f32_16x16x32_bf16 v[224:227], a[112:115], v[68:71], v[224:227]
    v_mfma_f32_16x16x32_bf16 v[228:231], a[116:119], v[68:71], v[228:231]
    v_mfma_f32_16x16x32_bf16 v[232:235], a[120:123], v[68:71], v[232:235]
    v_mfma_f32_16x16x32_bf16 v[236:239], a[124:127], v[68:71], v[236:239]
    v_mfma_f32_16x16x32_bf16 v[240:243], a[112:115], v[72:75], v[240:243]
    v_mfma_f32_16x16x32_bf16 v[244:247], a[116:119], v[72:75], v[244:247]
    v_mfma_f32_16x16x32_bf16 v[248:251], a[120:123], v[72:75], v[248:251]
    v_mfma_f32_16x16x32_bf16 v[252:255], a[124:127], v[72:75], v[252:255]
    s_add_u32 s28, s41, 176128
    buffer_load_dwordx4 a[108:111], v5, s[12:15], s28 offen offset:2048
    v_mfma_f32_16x16x32_bf16 v[92:95], v[108:111], v[84:87], v[92:95]
    v_mfma_f32_16x16x32_bf16 v[96:99], v[84:87], v[84:87], v[96:99]
    v_mfma_f32_16x16x32_bf16 v[100:103], v[108:111], v[88:91], v[100:103]
    v_mfma_f32_16x16x32_bf16 v[104:107], v[88:91], v[88:91], v[104:107]
    s_waitcnt vmcnt(50)
    s_barrier
    s_waitcnt vmcnt(48)
    s_waitcnt lgkmcnt(0)
    ds_read_b128 v[44:47], v6 offset:16384
    ds_read_b128 v[48:51], v6 offset:17408
    ds_read_b128 v[52:55], v6 offset:18432
    ds_read_b128 v[56:59], v6 offset:19456
    ds_read_b128 v[60:63], v6 offset:20480
    ds_read_b128 v[64:67], v6 offset:21504
    ds_read_b128 v[68:71], v6 offset:22528
    ds_read_b128 v[72:75], v6 offset:23552
    ds_read_b128 v[84:87], v10 offset:16384
    ds_read_b128 v[88:91], v10 offset:17408
    v_mfma_f32_16x16x32_bf16 v[128:131], a[128:131], v[12:15], v[128:131]
    v_mfma_f32_16x16x32_bf16 v[132:135], a[132:135], v[12:15], v[132:135]
    v_mfma_f32_16x16x32_bf16 v[136:139], a[136:139], v[12:15], v[136:139]
    v_mfma_f32_16x16x32_bf16 v[140:143], a[140:143], v[12:15], v[140:143]
    v_mfma_f32_16x16x32_bf16 v[144:147], a[128:131], v[16:19], v[144:147]
    v_mfma_f32_16x16x32_bf16 v[148:151], a[132:135], v[16:19], v[148:151]
    v_mfma_f32_16x16x32_bf16 v[152:155], a[136:139], v[16:19], v[152:155]
    v_mfma_f32_16x16x32_bf16 v[156:159], a[140:143], v[16:19], v[156:159]
    s_add_u32 s28, s41, 4096
    buffer_load_dwordx4 a[112:115], v5, s[12:15], s28 offen offset:3072
    v_mfma_f32_16x16x32_bf16 v[160:163], a[128:131], v[20:23], v[160:163]
    v_mfma_f32_16x16x32_bf16 v[164:167], a[132:135], v[20:23], v[164:167]
    v_mfma_f32_16x16x32_bf16 v[168:171], a[136:139], v[20:23], v[168:171]
    v_mfma_f32_16x16x32_bf16 v[172:175], a[140:143], v[20:23], v[172:175]
    v_mfma_f32_16x16x32_bf16 v[176:179], a[128:131], v[24:27], v[176:179]
    v_mfma_f32_16x16x32_bf16 v[180:183], a[132:135], v[24:27], v[180:183]
    v_mfma_f32_16x16x32_bf16 v[184:187], a[136:139], v[24:27], v[184:187]
    v_mfma_f32_16x16x32_bf16 v[188:191], a[140:143], v[24:27], v[188:191]
    s_add_u32 s28, s41, 61440
    buffer_load_dwordx4 a[116:119], v5, s[12:15], s28 offen offset:3072
    v_mfma_f32_16x16x32_bf16 v[192:195], a[128:131], v[28:31], v[192:195]
    v_mfma_f32_16x16x32_bf16 v[196:199], a[132:135], v[28:31], v[196:199]
    v_mfma_f32_16x16x32_bf16 v[200:203], a[136:139], v[28:31], v[200:203]
    v_mfma_f32_16x16x32_bf16 v[204:207], a[140:143], v[28:31], v[204:207]
    v_mfma_f32_16x16x32_bf16 v[208:211], a[128:131], v[32:35], v[208:211]
    v_mfma_f32_16x16x32_bf16 v[212:215], a[132:135], v[32:35], v[212:215]
    v_mfma_f32_16x16x32_bf16 v[216:219], a[136:139], v[32:35], v[216:219]
    v_mfma_f32_16x16x32_bf16 v[220:223], a[140:143], v[32:35], v[220:223]
    s_add_u32 s28, s41, 118784
    buffer_load_dwordx4 a[120:123], v5, s[12:15], s28 offen offset:3072
    v_mfma_f32_16x16x32_bf16 v[224:227], a[128:131], v[36:39], v[224:227]
    v_mfma_f32_16x16x32_bf16 v[228:231], a[132:135], v[36:39], v[228:231]
    v_mfma_f32_16x16x32_bf16 v[232:235], a[136:139], v[36:39], v[232:235]
    v_mfma_f32_16x16x32_bf16 v[236:239], a[140:143], v[36:39], v[236:239]
    v_mfma_f32_16x16x32_bf16 v[240:243], a[128:131], v[40:43], v[240:243]
    v_mfma_f32_16x16x32_bf16 v[244:247], a[132:135], v[40:43], v[244:247]
    v_mfma_f32_16x16x32_bf16 v[248:251], a[136:139], v[40:43], v[248:251]
    v_mfma_f32_16x16x32_bf16 v[252:255], a[140:143], v[40:43], v[252:255]
    s_add_u32 s28, s41, 176128
    buffer_load_dwordx4 a[124:127], v5, s[12:15], s28 offen offset:3072
    v_mfma_f32_16x16x32_bf16 v[92:95], v[108:111], v[76:79], v[92:95]
    v_mfma_f32_16x16x32_bf16 v[96:99], v[76:79], v[76:79], v[96:99]
    v_mfma_f32_16x16x32_bf16 v[100:103], v[108:111], v[80:83], v[100:103]
    v_mfma_f32_16x16x32_bf16 v[104:107], v[80:83], v[80:83], v[104:107]
    s_waitcnt vmcnt(46)
    s_waitcnt lgkmcnt(0)
    ds_read_b128 v[12:15], v6 offset:24576
    ds_read_b128 v[16:19], v6 offset:25600
    ds_read_b128 v[20:23], v6 offset:26624
    ds_read_b128 v[24:27], v6 offset:27648
    ds_read_b128 v[28:31], v6 offset:28672
    ds_read_b128 v[32:35], v6 offset:29696
    ds_read_b128 v[36:39], v6 offset:30720
    ds_read_b128 v[40:43], v6 offset:31744
    ds_read_b128 v[76:79], v10 offset:24576
    ds_read_b128 v[80:83], v10 offset:25600
    v_mfma_f32_16x16x32_bf16 v[128:131], a[144:147], v[44:47], v[128:131]
    v_mfma_f32_16x16x32_bf16 v[132:135], a[148:151], v[44:47], v[132:135]
    v_mfma_f32_16x16x32_bf16 v[136:139], a[152:155], v[44:47], v[136:139]
    v_mfma_f32_16x16x32_bf16 v[140:143], a[156:159], v[44:47], v[140:143]
    v_mfma_f32_16x16x32_bf16 v[144:147], a[144:147], v[48:51], v[144:147]
    v_mfma_f32_16x16x32_bf16 v[148:151], a[148:151], v[48:51], v[148:151]
    v_mfma_f32_16x16x32_bf16 v[152:155], a[152:155], v[48:51], v[152:155]
    v_mfma_f32_16x16x32_bf16 v[156:159], a[156:159], v[48:51], v[156:159]
    s_add_u32 s28, s41, 8192
    buffer_load_dwordx4 a[128:131], v5, s[12:15], s28 offen offset:0
    v_mfma_f32_16x16x32_bf16 v[160:163], a[144:147], v[52:55], v[160:163]
    v_mfma_f32_16x16x32_bf16 v[164:167], a[148:151], v[52:55], v[164:167]
    v_mfma_f32_16x16x32_bf16 v[168:171], a[152:155], v[52:55], v[168:171]
    v_mfma_f32_16x16x32_bf16 v[172:175], a[156:159], v[52:55], v[172:175]
    v_mfma_f32_16x16x32_bf16 v[176:179], a[144:147], v[56:59], v[176:179]
    v_mfma_f32_16x16x32_bf16 v[180:183], a[148:151], v[56:59], v[180:183]
    v_mfma_f32_16x16x32_bf16 v[184:187], a[152:155], v[56:59], v[184:187]
    v_mfma_f32_16x16x32_bf16 v[188:191], a[156:159], v[56:59], v[188:191]
    s_add_u32 s28, s41, 65536
    buffer_load_dwordx4 a[132:135], v5, s[12:15], s28 offen offset:0
    v_mfma_f32_16x16x32_bf16 v[192:195], a[144:147], v[60:63], v[192:195]
    v_mfma_f32_16x16x32_bf16 v[196:199], a[148:151], v[60:63], v[196:199]
    v_mfma_f32_16x16x32_bf16 v[200:203], a[152:155], v[60:63], v[200:203]
    v_mfma_f32_16x16x32_bf16 v[204:207], a[156:159], v[60:63], v[204:207]
    v_mfma_f32_16x16x32_bf16 v[208:211], a[144:147], v[64:67], v[208:211]
    v_mfma_f32_16x16x32_bf16 v[212:215], a[148:151], v[64:67], v[212:215]
    v_mfma_f32_16x16x32_bf16 v[216:219], a[152:155], v[64:67], v[216:219]
    v_mfma_f32_16x16x32_bf16 v[220:223], a[156:159], v[64:67], v[220:223]
    s_add_u32 s28, s41, 122880
    buffer_load_dwordx4 a[136:139], v5, s[12:15], s28 offen offset:0
    v_mfma_f32_16x16x32_bf16 v[224:227], a[144:147], v[68:71], v[224:227]
    v_mfma_f32_16x16x32_bf16 v[228:231], a[148:151], v[68:71], v[228:231]
    v_mfma_f32_16x16x32_bf16 v[232:235], a[152:155], v[68:71], v[232:235]
    v_mfma_f32_16x16x32_bf16 v[236:239], a[156:159], v[68:71], v[236:239]
    v_mfma_f32_16x16x32_bf16 v[240:243], a[144:147], v[72:75], v[240:243]
    v_mfma_f32_16x16x32_bf16 v[244:247], a[148:151], v[72:75], v[244:247]
    v_mfma_f32_16x16x32_bf16 v[248:251], a[152:155], v[72:75], v[248:251]
    v_mfma_f32_16x16x32_bf16 v[252:255], a[156:159], v[72:75], v[252:255]
    s_add_u32 s28, s41, 180224
    buffer_load_dwordx4 a[140:143], v5, s[12:15], s28 offen offset:0
    v_mfma_f32_16x16x32_bf16 v[92:95], v[108:111], v[84:87], v[92:95]
    v_mfma_f32_16x16x32_bf16 v[96:99], v[84:87], v[84:87], v[96:99]
    v_mfma_f32_16x16x32_bf16 v[100:103], v[108:111], v[88:91], v[100:103]
    v_mfma_f32_16x16x32_bf16 v[104:107], v[88:91], v[88:91], v[104:107]
    s_waitcnt vmcnt(44)
    s_waitcnt lgkmcnt(0)
    ds_read_b128 v[44:47], v6 offset:32768
    ds_read_b128 v[48:51], v6 offset:33792
    ds_read_b128 v[52:55], v6 offset:34816
    ds_read_b128 v[56:59], v6 offset:35840
    ds_read_b128 v[60:63], v6 offset:36864
    ds_read_b128 v[64:67], v6 offset:37888
    ds_read_b128 v[68:71], v6 offset:38912
    ds_read_b128 v[72:75], v6 offset:39936
    ds_read_b128 v[84:87], v10 offset:32768
    ds_read_b128 v[88:91], v10 offset:33792
    v_mfma_f32_16x16x32_bf16 v[128:131], a[160:163], v[12:15], v[128:131]
    v_mfma_f32_16x16x32_bf16 v[132:135], a[164:167], v[12:15], v[132:135]
    v_mfma_f32_16x16x32_bf16 v[136:139], a[168:171], v[12:15], v[136:139]
    v_mfma_f32_16x16x32_bf16 v[140:143], a[172:175], v[12:15], v[140:143]
    v_mfma_f32_16x16x32_bf16 v[144:147], a[160:163], v[16:19], v[144:147]
    v_mfma_f32_16x16x32_bf16 v[148:151], a[164:167], v[16:19], v[148:151]
    v_mfma_f32_16x16x32_bf16 v[152:155], a[168:171], v[16:19], v[152:155]
    v_mfma_f32_16x16x32_bf16 v[156:159], a[172:175], v[16:19], v[156:159]
    s_add_u32 s28, s41, 8192
    buffer_load_dwordx4 a[144:147], v5, s[12:15], s28 offen offset:1024
    v_mfma_f32_16x16x32_bf16 v[160:163], a[160:163], v[20:23], v[160:163]
    v_mfma_f32_16x16x32_bf16 v[164:167], a[164:167], v[20:23], v[164:167]
    v_mfma_f32_16x16x32_bf16 v[168:171], a[168:171], v[20:23], v[168:171]
    v_mfma_f32_16x16x32_bf16 v[172:175], a[172:175], v[20:23], v[172:175]
    v_mfma_f32_16x16x32_bf16 v[176:179], a[160:163], v[24:27], v[176:179]
    v_mfma_f32_16x16x32_bf16 v[180:183], a[164:167], v[24:27], v[180:183]
    v_mfma_f32_16x16x32_bf16 v[184:187], a[168:171], v[24:27], v[184:187]
    v_mfma_f32_16x16x32_bf16 v[188:191], a[172:175], v[24:27], v[188:191]
    s_add_u32 s28, s41, 65536
    buffer_load_dwordx4 a[148:151], v5, s[12:15], s28 offen offset:1024
    v_mfma_f32_16x16x32_bf16 v[192:195], a[160:163], v[28:31], v[192:195]
    v_mfma_f32_16x16x32_bf16 v[196:199], a[164:167], v[28:31], v[196:199]
    v_mfma_f32_16x16x32_bf16 v[200:203], a[168:171], v[28:31], v[200:203]
    v_mfma_f32_16x16x32_bf16 v[204:207], a[172:175], v[28:31], v[204:207]
    v_mfma_f32_16x16x32_bf16 v[208:211], a[160:163], v[32:35], v[208:211]
    v_mfma_f32_16x16x32_bf16 v[212:215], a[164:167], v[32:35], v[212:215]
    v_mfma_f32_16x16x32_bf16 v[216:219], a[168:171], v[32:35], v[216:219]
    v_mfma_f32_16x16x32_bf16 v[220:223], a[172:175], v[32:35], v[220:223]
    s_add_u32 s28, s41, 122880
    buffer_load_dwordx4 a[152:155], v5, s[12:15], s28 offen offset:1024
    v_mfma_f32_16x16x32_bf16 v[224:227], a[160:163], v[36:39], v[224:227]
    v_mfma_f32_16x16x32_bf16 v[228:231], a[164:167], v[36:39], v[228:231]
    v_mfma_f32_16x16x32_bf16 v[232:235], a[168:171], v[36:39], v[232:235]
    v_mfma_f32_16x16x32_bf16 v[236:239], a[172:175], v[36:39], v[236:239]
    v_mfma_f32_16x16x32_bf16 v[240:243], a[160:163], v[40:43], v[240:243]
    v_mfma_f32_16x16x32_bf16 v[244:247], a[164:167], v[40:43], v[244:247]
    v_mfma_f32_16x16x32_bf16 v[248:251], a[168:171], v[40:43], v[248:251]
    v_mfma_f32_16x16x32_bf16 v[252:255], a[172:175], v[40:43], v[252:255]
    s_add_u32 s28, s41, 180224
    buffer_load_dwordx4 a[156:159], v5, s[12:15], s28 offen offset:1024
    v_mfma_f32_16x16x32_bf16 v[92:95], v[108:111], v[76:79], v[92:95]
    v_mfma_f32_16x16x32_bf16 v[96:99], v[76:79], v[76:79], v[96:99]
    v_mfma_f32_16x16x32_bf16 v[100:103], v[108:111], v[80:83], v[100:103]
    v_mfma_f32_16x16x32_bf16 v[104:107], v[80:83], v[80:83], v[104:107]
    s_waitcnt vmcnt(42)
    s_waitcnt lgkmcnt(0)
    ds_read_b128 v[12:15], v6 offset:40960
    ds_read_b128 v[16:19], v6 offset:41984
    ds_read_b128 v[20:23], v6 offset:43008
    ds_read_b128 v[24:27], v6 offset:44032
    ds_read_b128 v[28:31], v6 offset:45056
    ds_read_b128 v[32:35], v6 offset:46080
    ds_read_b128 v[36:39], v6 offset:47104
    ds_read_b128 v[40:43], v6 offset:48128
    ds_read_b128 v[76:79], v10 offset:40960
    ds_read_b128 v[80:83], v10 offset:41984
    v_mfma_f32_16x16x32_bf16 v[128:131], a[176:179], v[44:47], v[128:131]
    v_mfma_f32_16x16x32_bf16 v[132:135], a[180:183], v[44:47], v[132:135]
    v_mfma_f32_16x16x32_bf16 v[136:139], a[184:187], v[44:47], v[136:139]
    v_mfma_f32_16x16x32_bf16 v[140:143], a[188:191], v[44:47], v[140:143]
    v_mfma_f32_16x16x32_bf16 v[144:147], a[176:179], v[48:51], v[144:147]
    v_mfma_f32_16x16x32_bf16 v[148:151], a[180:183], v[48:51], v[148:151]
    v_mfma_f32_16x16x32_bf16 v[152:155], a[184:187], v[48:51], v[152:155]
    v_mfma_f32_16x16x32_bf16 v[156:159], a[188:191], v[48:51], v[156:159]
    s_add_u32 s28, s41, 8192
    buffer_load_dwordx4 a[160:163], v5, s[12:15], s28 offen offset:2048
    v_mfma_f32_16x16x32_bf16 v[160:163], a[176:179], v[52:55], v[160:163]
    v_mfma_f32_16x16x32_bf16 v[164:167], a[180:183], v[52:55], v[164:167]
    v_mfma_f32_16x16x32_bf16 v[168:171], a[184:187], v[52:55], v[168:171]
    v_mfma_f32_16x16x32_bf16 v[172:175], a[188:191], v[52:55], v[172:175]
    v_mfma_f32_16x16x32_bf16 v[176:179], a[176:179], v[56:59], v[176:179]
    v_mfma_f32_16x16x32_bf16 v[180:183], a[180:183], v[56:59], v[180:183]
    v_mfma_f32_16x16x32_bf16 v[184:187], a[184:187], v[56:59], v[184:187]
    v_mfma_f32_16x16x32_bf16 v[188:191], a[188:191], v[56:59], v[188:191]
    s_add_u32 s28, s41, 65536
    buffer_load_dwordx4 a[164:167], v5, s[12:15], s28 offen offset:2048
    v_mfma_f32_16x16x32_bf16 v[192:195], a[176:179], v[60:63], v[192:195]
    v_mfma_f32_16x16x32_bf16 v[196:199], a[180:183], v[60:63], v[196:199]
    v_mfma_f32_16x16x32_bf16 v[200:203], a[184:187], v[60:63], v[200:203]
    v_mfma_f32_16x16x32_bf16 v[204:207], a[188:191], v[60:63], v[204:207]
    v_mfma_f32_16x16x32_bf16 v[208:211], a[176:179], v[64:67], v[208:211]
    v_mfma_f32_16x16x32_bf16 v[212:215], a[180:183], v[64:67], v[212:215]
    v_mfma_f32_16x16x32_bf16 v[216:219], a[184:187], v[64:67], v[216:219]
    v_mfma_f32_16x16x32_bf16 v[220:223], a[188:191], v[64:67], v[220:223]
    s_add_u32 s28, s41, 122880
    buffer_load_dwordx4 a[168:171], v5, s[12:15], s28 offen offset:2048
    v_mfma_f32_16x16x32_bf16 v[224:227], a[176:179], v[68:71], v[224:227]
    v_mfma_f32_16x16x32_bf16 v[228:231], a[180:183], v[68:71], v[228:231]
    v_mfma_f32_16x16x32_bf16 v[232:235], a[184:187], v[68:71], v[232:235]
    v_mfma_f32_16x16x32_bf16 v[236:239], a[188:191], v[68:71], v[236:239]
    v_mfma_f32_16x16x32_bf16 v[240:243], a[176:179], v[72:75], v[240:243]
    v_mfma_f32_16x16x32_bf16 v[244:247], a[180:183], v[72:75], v[244:247]
    v_mfma_f32_16x16x32_bf16 v[248:251], a[184:187], v[72:75], v[248:251]
    v_mfma_f32_16x16x32_bf16 v[252:255], a[188:191], v[72:75], v[252:255]
    s_add_u32 s28, s41, 180224
    buffer_load_dwordx4 a[172:175], v5, s[12:15], s28 offen offset:2048
    v_mfma_f32_16x16x32_bf16 v[92:95], v[108:111], v[84:87], v[92:95]
    v_mfma_f32_16x16x32_bf16 v[96:99], v[84:87], v[84:87], v[96:99]
    v_mfma_f32_16x16x32_bf16 v[100:103], v[108:111], v[88:91], v[100:103]
    v_mfma_f32_16x16x32_bf16 v[104:107], v[88:91], v[88:91], v[104:107]
    s_waitcnt vmcnt(40)
    s_waitcnt lgkmcnt(0)
    ds_read_b128 v[44:47], v6 offset:49152
    ds_read_b128 v[48:51], v6 offset:50176
    ds_read_b128 v[52:55], v6 offset:51200
    ds_read_b128 v[56:59], v6 offset:52224
    ds_read_b128 v[60:63], v6 offset:53248
    ds_read_b128 v[64:67], v6 offset:54272
    ds_read_b128 v[68:71], v6 offset:55296
    ds_read_b128 v[72:75], v6 offset:56320
    ds_read_b128 v[84:87], v10 offset:49152
    ds_read_b128 v[88:91], v10 offset:50176
    v_mfma_f32_16x16x32_bf16 v[128:131], a[192:195], v[12:15], v[128:131]
    v_mfma_f32_16x16x32_bf16 v[132:135], a[196:199], v[12:15], v[132:135]
    v_mfma_f32_16x16x32_bf16 v[136:139], a[200:203], v[12:15], v[136:139]
    v_mfma_f32_16x16x32_bf16 v[140:143], a[204:207], v[12:15], v[140:143]
    v_mfma_f32_16x16x32_bf16 v[144:147], a[192:195], v[16:19], v[144:147]
    v_mfma_f32_16x16x32_bf16 v[148:151], a[196:199], v[16:19], v[148:151]
    v_mfma_f32_16x16x32_bf16 v[152:155], a[200:203], v[16:19], v[152:155]
    v_mfma_f32_16x16x32_bf16 v[156:159], a[204:207], v[16:19], v[156:159]
    s_add_u32 s28, s41, 8192
    buffer_load_dwordx4 a[176:179], v5, s[12:15], s28 offen offset:3072
    v_mfma_f32_16x16x32_bf16 v[160:163], a[192:195], v[20:23], v[160:163]
    v_mfma_f32_16x16x32_bf16 v[164:167], a[196:199], v[20:23], v[164:167]
    v_mfma_f32_16x16x32_bf16 v[168:171], a[200:203], v[20:23], v[168:171]
    v_mfma_f32_16x16x32_bf16 v[172:175], a[204:207], v[20:23], v[172:175]
    v_mfma_f32_16x16x32_bf16 v[176:179], a[192:195], v[24:27], v[176:179]
    v_mfma_f32_16x16x32_bf16 v[180:183], a[196:199], v[24:27], v[180:183]
    v_mfma_f32_16x16x32_bf16 v[184:187], a[200:203], v[24:27], v[184:187]
    v_mfma_f32_16x16x32_bf16 v[188:191], a[204:207], v[24:27], v[188:191]
    s_add_u32 s28, s41, 65536
    buffer_load_dwordx4 a[180:183], v5, s[12:15], s28 offen offset:3072
    v_mfma_f32_16x16x32_bf16 v[192:195], a[192:195], v[28:31], v[192:195]
    v_mfma_f32_16x16x32_bf16 v[196:199], a[196:199], v[28:31], v[196:199]
    v_mfma_f32_16x16x32_bf16 v[200:203], a[200:203], v[28:31], v[200:203]
    v_mfma_f32_16x16x32_bf16 v[204:207], a[204:207], v[28:31], v[204:207]
    v_mfma_f32_16x16x32_bf16 v[208:211], a[192:195], v[32:35], v[208:211]
    v_mfma_f32_16x16x32_bf16 v[212:215], a[196:199], v[32:35], v[212:215]
    v_mfma_f32_16x16x32_bf16 v[216:219], a[200:203], v[32:35], v[216:219]
    v_mfma_f32_16x16x32_bf16 v[220:223], a[204:207], v[32:35], v[220:223]
    s_add_u32 s28, s41, 122880
    buffer_load_dwordx4 a[184:187], v5, s[12:15], s28 offen offset:3072
    v_mfma_f32_16x16x32_bf16 v[224:227], a[192:195], v[36:39], v[224:227]
    v_mfma_f32_16x16x32_bf16 v[228:231], a[196:199], v[36:39], v[228:231]
    v_mfma_f32_16x16x32_bf16 v[232:235], a[200:203], v[36:39], v[232:235]
    v_mfma_f32_16x16x32_bf16 v[236:239], a[204:207], v[36:39], v[236:239]
    v_mfma_f32_16x16x32_bf16 v[240:243], a[192:195], v[40:43], v[240:243]
    v_mfma_f32_16x16x32_bf16 v[244:247], a[196:199], v[40:43], v[244:247]
    v_mfma_f32_16x16x32_bf16 v[248:251], a[200:203], v[40:43], v[248:251]
    v_mfma_f32_16x16x32_bf16 v[252:255], a[204:207], v[40:43], v[252:255]
    s_add_u32 s28, s41, 180224
    buffer_load_dwordx4 a[188:191], v5, s[12:15], s28 offen offset:3072
    v_mfma_f32_16x16x32_bf16 v[92:95], v[108:111], v[76:79], v[92:95]
    v_mfma_f32_16x16x32_bf16 v[96:99], v[76:79], v[76:79], v[96:99]
    v_mfma_f32_16x16x32_bf16 v[100:103], v[108:111], v[80:83], v[100:103]
    v_mfma_f32_16x16x32_bf16 v[104:107], v[80:83], v[80:83], v[104:107]
    s_waitcnt vmcnt(38)
    s_waitcnt lgkmcnt(0)
    v_mfma_f32_16x16x32_bf16 v[128:131], a[208:211], v[44:47], v[128:131]
    v_mfma_f32_16x16x32_bf16 v[132:135], a[212:215], v[44:47], v[132:135]
    v_mfma_f32_16x16x32_bf16 v[136:139], a[216:219], v[44:47], v[136:139]
    v_mfma_f32_16x16x32_bf16 v[140:143], a[220:223], v[44:47], v[140:143]
    v_mfma_f32_16x16x32_bf16 v[144:147], a[208:211], v[48:51], v[144:147]
    v_mfma_f32_16x16x32_bf16 v[148:151], a[212:215], v[48:51], v[148:151]
    v_mfma_f32_16x16x32_bf16 v[152:155], a[216:219], v[48:51], v[152:155]
    v_mfma_f32_16x16x32_bf16 v[156:159], a[220:223], v[48:51], v[156:159]
    s_add_u32 s28, s41, 12288
    buffer_load_dwordx4 a[192:195], v5, s[12:15], s28 offen offset:0
    v_mfma_f32_16x16x32_bf16 v[160:163], a[208:211], v[52:55], v[160:163]
    v_mfma_f32_16x16x32_bf16 v[164:167], a[212:215], v[52:55], v[164:167]
    v_mfma_f32_16x16x32_bf16 v[168:171], a[216:219], v[52:55], v[168:171]
    v_mfma_f32_16x16x32_bf16 v[172:175], a[220:223], v[52:55], v[172:175]
    v_mfma_f32_16x16x32_bf16 v[176:179], a[208:211], v[56:59], v[176:179]
    v_mfma_f32_16x16x32_bf16 v[180:183], a[212:215], v[56:59], v[180:183]
    v_mfma_f32_16x16x32_bf16 v[184:187], a[216:219], v[56:59], v[184:187]
    v_mfma_f32_16x16x32_bf16 v[188:191], a[220:223], v[56:59], v[188:191]
    s_add_u32 s28, s41, 69632
    buffer_load_dwordx4 a[196:199], v5, s[12:15], s28 offen offset:0
    v_mfma_f32_16x16x32_bf16 v[192:195], a[208:211], v[60:63], v[192:195]
    v_mfma_f32_16x16x32_bf16 v[196:199], a[212:215], v[60:63], v[196:199]
    v_mfma_f32_16x16x32_bf16 v[200:203], a[216:219], v[60:63], v[200:203]
    v_mfma_f32_16x16x32_bf16 v[204:207], a[220:223], v[60:63], v[204:207]
    v_mfma_f32_16x16x32_bf16 v[208:211], a[208:211], v[64:67], v[208:211]
    v_mfma_f32_16x16x32_bf16 v[212:215], a[212:215], v[64:67], v[212:215]
    v_mfma_f32_16x16x32_bf16 v[216:219], a[216:219], v[64:67], v[216:219]
    v_mfma_f32_16x16x32_bf16 v[220:223], a[220:223], v[64:67], v[220:223]
    s_add_u32 s28, s41, 126976
    buffer_load_dwordx4 a[200:203], v5, s[12:15], s28 offen offset:0
    v_mfma_f32_16x16x32_bf16 v[224:227], a[208:211], v[68:71], v[224:227]
    v_mfma_f32_16x16x32_bf16 v[228:231], a[212:215], v[68:71], v[228:231]
    v_mfma_f32_16x16x32_bf16 v[232:235], a[216:219], v[68:71], v[232:235]
    v_mfma_f32_16x16x32_bf16 v[236:239], a[220:223], v[68:71], v[236:239]
    v_mfma_f32_16x16x32_bf16 v[240:243], a[208:211], v[72:75], v[240:243]
    v_mfma_f32_16x16x32_bf16 v[244:247], a[212:215], v[72:75], v[244:247]
    v_mfma_f32_16x16x32_bf16 v[248:251], a[216:219], v[72:75], v[248:251]
    v_mfma_f32_16x16x32_bf16 v[252:255], a[220:223], v[72:75], v[252:255]
    s_add_u32 s28, s41, 184320
    buffer_load_dwordx4 a[204:207], v5, s[12:15], s28 offen offset:0
    v_mfma_f32_16x16x32_bf16 v[92:95], v[108:111], v[84:87], v[92:95]
    v_mfma_f32_16x16x32_bf16 v[96:99], v[84:87], v[84:87], v[96:99]
    v_mfma_f32_16x16x32_bf16 v[100:103], v[108:111], v[88:91], v[100:103]
    v_mfma_f32_16x16x32_bf16 v[104:107], v[88:91], v[88:91], v[104:107]
    s_nop 7
    s_nop 1
    v_and_b32 v28, 3, v3
    v_lshrrev_b32 v29, 2, v3
    v_cmp_eq_u32 vcc, 1, v28
    s_nop 1
    v_cndmask_b32 v93, v96, v97, vcc
    v_cmp_eq_u32 vcc, 2, v28
    s_nop 1
    v_cndmask_b32 v93, v93, v98, vcc
    v_cmp_eq_u32 vcc, 3, v28
    s_nop 1
    v_cndmask_b32 v93, v93, v99, vcc
    v_mul_f32 v92, 0x3b124925, v92
    v_mul_f32 v93, 0x3b124925, v93
    v_fma_f32 v93, -v92, v92, v93
    v_max_f32 v93, 0, v93
    v_cvt_pk_bf16_f32 v93, v93, v93
    v_lshlrev_b32 v93, 16, v93
    v_add_f32 v93, 0x3727c5ac, v93
    v_cvt_pk_bf16_f32 v93, v93, v93
    v_lshlrev_b32 v93, 16, v93
    v_sqrt_f32 v93, v93
    s_nop 0
    v_cvt_pk_bf16_f32 v93, v93, v93
    v_lshlrev_b32 v93, 16, v93
    v_rcp_f32 v93, v93
    v_cvt_pk_bf16_f32 v92, v92, v92
    v_lshlrev_b32 v92, 16, v92
    v_cmp_eq_u32 vcc, 1, v28
    s_nop 1
    v_cndmask_b32 v101, v104, v105, vcc
    v_cmp_eq_u32 vcc, 2, v28
    s_nop 1
    v_cndmask_b32 v101, v101, v106, vcc
    v_cmp_eq_u32 vcc, 3, v28
    s_nop 1
    v_cndmask_b32 v101, v101, v107, vcc
    v_mul_f32 v100, 0x3b124925, v100
    v_mul_f32 v101, 0x3b124925, v101
    v_fma_f32 v101, -v100, v100, v101
    v_max_f32 v101, 0, v101
    v_cvt_pk_bf16_f32 v101, v101, v101
    v_lshlrev_b32 v101, 16, v101
    v_add_f32 v101, 0x3727c5ac, v101
    v_cvt_pk_bf16_f32 v101, v101, v101
    v_lshlrev_b32 v101, 16, v101
    v_sqrt_f32 v101, v101
    s_nop 0
    v_cvt_pk_bf16_f32 v101, v101, v101
    v_lshlrev_b32 v101, 16, v101
    v_rcp_f32 v101, v101
    v_cvt_pk_bf16_f32 v100, v100, v100
    v_lshlrev_b32 v100, 16, v100
    s_lshl_b32 s27, s3, 8
    s_add_u32 s27, s27, 114688
    v_lshl_add_u32 v28, v3, 3, s27
    v_cmp_eq_u32 vcc, v29, v2
    s_and_saveexec_b64 s[44:45], vcc
    ds_write_b64 v28, v[92:93] offset:0
    ds_write_b64 v28, v[100:101] offset:128
    s_mov_b64 exec, s[44:45]
    s_waitcnt lgkmcnt(0)
    s_barrier
    v_lshlrev_b32 v28, 3, v3
    v_add_u32 v28, 114688, v28
    ds_read_b64 v[12:13], v28 offset:0
    ds_read_b64 v[14:15], v28 offset:128
    ds_read_b64 v[16:17], v28 offset:256
    ds_read_b64 v[18:19], v28 offset:384
    ds_read_b64 v[20:21], v28 offset:512
    ds_read_b64 v[22:23], v28 offset:640
    ds_read_b64 v[24:25], v28 offset:768
    ds_read_b64 v[26:27], v28 offset:896
    s_waitcnt lgkmcnt(0)
    s_mul_i32 s30, s20, 458752
    s_lshl_b32 s35, s21, 2
    s_add_u32 s35, s35, s3
    s_lshl_b32 s35, s35, 10
    s_add_u32 s30, s30, s35
    v_mul_f32 v13, v13, v13
    v_pk_fma_f32 v[128:129], v[112:113], v[12:13], v[128:129] op_sel:[0,0,0] op_sel_hi:[1,0,1] neg_lo:[0,1,0] neg_hi:[0,1,0]
    v_pk_fma_f32 v[136:137], v[120:121], v[12:13], v[136:137] op_sel:[0,0,0] op_sel_hi:[1,0,1] neg_lo:[0,1,0] neg_hi:[0,1,0]
    v_pk_mul_f32 v[128:129], v[128:129], v[136:137]
    v_pk_mul_f32 v[128:129], v[128:129], v[12:13] op_sel:[0,1] op_sel_hi:[1,1]
    v_cvt_pk_bf16_f32 v32, v128, v129
    v_pk_fma_f32 v[130:131], v[114:115], v[12:13], v[130:131] op_sel:[0,0,0] op_sel_hi:[1,0,1] neg_lo:[0,1,0] neg_hi:[0,1,0]
    v_pk_fma_f32 v[138:139], v[122:123], v[12:13], v[138:139] op_sel:[0,0,0] op_sel_hi:[1,0,1] neg_lo:[0,1,0] neg_hi:[0,1,0]
    v_pk_mul_f32 v[130:131], v[130:131], v[138:139]
    v_pk_mul_f32 v[130:131], v[130:131], v[12:13] op_sel:[0,1] op_sel_hi:[1,1]
    v_cvt_pk_bf16_f32 v33, v130, v131
    v_pk_fma_f32 v[132:133], v[116:117], v[12:13], v[132:133] op_sel:[0,0,0] op_sel_hi:[1,0,1] neg_lo:[0,1,0] neg_hi:[0,1,0]
    v_pk_fma_f32 v[140:141], v[124:125], v[12:13], v[140:141] op_sel:[0,0,0] op_sel_hi:[1,0,1] neg_lo:[0,1,0] neg_hi:[0,1,0]
    v_pk_mul_f32 v[132:133], v[132:133], v[140:141]
    v_pk_mul_f32 v[132:133], v[132:133], v[12:13] op_sel:[0,1] op_sel_hi:[1,1]
    v_cvt_pk_bf16_f32 v34, v132, v133
    v_pk_fma_f32 v[134:135], v[118:119], v[12:13], v[134:135] op_sel:[0,0,0] op_sel_hi:[1,0,1] neg_lo:[0,1,0] neg_hi:[0,1,0]
    v_pk_fma_f32 v[142:143], v[126:127], v[12:13], v[142:143] op_sel:[0,0,0] op_sel_hi:[1,0,1] neg_lo:[0,1,0] neg_hi:[0,1,0]
    v_pk_mul_f32 v[134:135], v[134:135], v[142:143]
    v_pk_mul_f32 v[134:135], v[134:135], v[12:13] op_sel:[0,1] op_sel_hi:[1,1]
    v_cvt_pk_bf16_f32 v35, v134, v135
    s_add_u32 s35, s30, 0
    buffer_store_dwordx4 v[32:35], v5, s[16:19], s35 offen sc0 sc1
    v_mul_f32 v15, v15, v15
    v_pk_fma_f32 v[144:145], v[112:113], v[14:15], v[144:145] op_sel:[0,0,0] op_sel_hi:[1,0,1] neg_lo:[0,1,0] neg_hi:[0,1,0]
    v_pk_fma_f32 v[152:153], v[120:121], v[14:15], v[152:153] op_sel:[0,0,0] op_sel_hi:[1,0,1] neg_lo:[0,1,0] neg_hi:[0,1,0]
    v_pk_mul_f32 v[144:145], v[144:145], v[152:153]
    v_pk_mul_f32 v[144:145], v[144:145], v[14:15] op_sel:[0,1] op_sel_hi:[1,1]
    v_cvt_pk_bf16_f32 v36, v144, v145
    v_pk_fma_f32 v[146:147], v[114:115], v[14:15], v[146:147] op_sel:[0,0,0] op_sel_hi:[1,0,1] neg_lo:[0,1,0] neg_hi:[0,1,0]
    v_pk_fma_f32 v[154:155], v[122:123], v[14:15], v[154:155] op_sel:[0,0,0] op_sel_hi:[1,0,1] neg_lo:[0,1,0] neg_hi:[0,1,0]
    v_pk_mul_f32 v[146:147], v[146:147], v[154:155]
    v_pk_mul_f32 v[146:147], v[146:147], v[14:15] op_sel:[0,1] op_sel_hi:[1,1]
    v_cvt_pk_bf16_f32 v37, v146, v147
    v_pk_fma_f32 v[148:149], v[116:117], v[14:15], v[148:149] op_sel:[0,0,0] op_sel_hi:[1,0,1] neg_lo:[0,1,0] neg_hi:[0,1,0]
    v_pk_fma_f32 v[156:157], v[124:125], v[14:15], v[156:157] op_sel:[0,0,0] op_sel_hi:[1,0,1] neg_lo:[0,1,0] neg_hi:[0,1,0]
    v_pk_mul_f32 v[148:149], v[148:149], v[156:157]
    v_pk_mul_f32 v[148:149], v[148:149], v[14:15] op_sel:[0,1] op_sel_hi:[1,1]
    v_cvt_pk_bf16_f32 v38, v148, v149
    v_pk_fma_f32 v[150:151], v[118:119], v[14:15], v[150:151] op_sel:[0,0,0] op_sel_hi:[1,0,1] neg_lo:[0,1,0] neg_hi:[0,1,0]
    v_pk_fma_f32 v[158:159], v[126:127], v[14:15], v[158:159] op_sel:[0,0,0] op_sel_hi:[1,0,1] neg_lo:[0,1,0] neg_hi:[0,1,0]
    v_pk_mul_f32 v[150:151], v[150:151], v[158:159]
    v_pk_mul_f32 v[150:151], v[150:151], v[14:15] op_sel:[0,1] op_sel_hi:[1,1]
    v_cvt_pk_bf16_f32 v39, v150, v151
    s_add_u32 s35, s30, 57344
    buffer_store_dwordx4 v[36:39], v5, s[16:19], s35 offen sc0 sc1
    v_mul_f32 v17, v17, v17
    v_pk_fma_f32 v[160:161], v[112:113], v[16:17], v[160:161] op_sel:[0,0,0] op_sel_hi:[1,0,1] neg_lo:[0,1,0] neg_hi:[0,1,0]
    v_pk_fma_f32 v[168:169], v[120:121], v[16:17], v[168:169] op_sel:[0,0,0] op_sel_hi:[1,0,1] neg_lo:[0,1,0] neg_hi:[0,1,0]
    v_pk_mul_f32 v[160:161], v[160:161], v[168:169]
    v_pk_mul_f32 v[160:161], v[160:161], v[16:17] op_sel:[0,1] op_sel_hi:[1,1]
    v_cvt_pk_bf16_f32 v32, v160, v161
    v_pk_fma_f32 v[162:163], v[114:115], v[16:17], v[162:163] op_sel:[0,0,0] op_sel_hi:[1,0,1] neg_lo:[0,1,0] neg_hi:[0,1,0]
    v_pk_fma_f32 v[170:171], v[122:123], v[16:17], v[170:171] op_sel:[0,0,0] op_sel_hi:[1,0,1] neg_lo:[0,1,0] neg_hi:[0,1,0]
    v_pk_mul_f32 v[162:163], v[162:163], v[170:171]
    v_pk_mul_f32 v[162:163], v[162:163], v[16:17] op_sel:[0,1] op_sel_hi:[1,1]
    v_cvt_pk_bf16_f32 v33, v162, v163
    v_pk_fma_f32 v[164:165], v[116:117], v[16:17], v[164:165] op_sel:[0,0,0] op_sel_hi:[1,0,1] neg_lo:[0,1,0] neg_hi:[0,1,0]
    v_pk_fma_f32 v[172:173], v[124:125], v[16:17], v[172:173] op_sel:[0,0,0] op_sel_hi:[1,0,1] neg_lo:[0,1,0] neg_hi:[0,1,0]
    v_pk_mul_f32 v[164:165], v[164:165], v[172:173]
    v_pk_mul_f32 v[164:165], v[164:165], v[16:17] op_sel:[0,1] op_sel_hi:[1,1]
    v_cvt_pk_bf16_f32 v34, v164, v165
    v_pk_fma_f32 v[166:167], v[118:119], v[16:17], v[166:167] op_sel:[0,0,0] op_sel_hi:[1,0,1] neg_lo:[0,1,0] neg_hi:[0,1,0]
    v_pk_fma_f32 v[174:175], v[126:127], v[16:17], v[174:175] op_sel:[0,0,0] op_sel_hi:[1,0,1] neg_lo:[0,1,0] neg_hi:[0,1,0]
    v_pk_mul_f32 v[166:167], v[166:167], v[174:175]
    v_pk_mul_f32 v[166:167], v[166:167], v[16:17] op_sel:[0,1] op_sel_hi:[1,1]
    v_cvt_pk_bf16_f32 v35, v166, v167
    s_add_u32 s35, s30, 114688
    buffer_store_dwordx4 v[32:35], v5, s[16:19], s35 offen sc0 sc1
    v_mul_f32 v19, v19, v19
    v_pk_fma_f32 v[176:177], v[112:113], v[18:19], v[176:177] op_sel:[0,0,0] op_sel_hi:[1,0,1] neg_lo:[0,1,0] neg_hi:[0,1,0]
    v_pk_fma_f32 v[184:185], v[120:121], v[18:19], v[184:185] op_sel:[0,0,0] op_sel_hi:[1,0,1] neg_lo:[0,1,0] neg_hi:[0,1,0]
    v_pk_mul_f32 v[176:177], v[176:177], v[184:185]
    v_pk_mul_f32 v[176:177], v[176:177], v[18:19] op_sel:[0,1] op_sel_hi:[1,1]
    v_cvt_pk_bf16_f32 v36, v176, v177
    v_pk_fma_f32 v[178:179], v[114:115], v[18:19], v[178:179] op_sel:[0,0,0] op_sel_hi:[1,0,1] neg_lo:[0,1,0] neg_hi:[0,1,0]
    v_pk_fma_f32 v[186:187], v[122:123], v[18:19], v[186:187] op_sel:[0,0,0] op_sel_hi:[1,0,1] neg_lo:[0,1,0] neg_hi:[0,1,0]
    v_pk_mul_f32 v[178:179], v[178:179], v[186:187]
    v_pk_mul_f32 v[178:179], v[178:179], v[18:19] op_sel:[0,1] op_sel_hi:[1,1]
    v_cvt_pk_bf16_f32 v37, v178, v179
    v_pk_fma_f32 v[180:181], v[116:117], v[18:19], v[180:181] op_sel:[0,0,0] op_sel_hi:[1,0,1] neg_lo:[0,1,0] neg_hi:[0,1,0]
    v_pk_fma_f32 v[188:189], v[124:125], v[18:19], v[188:189] op_sel:[0,0,0] op_sel_hi:[1,0,1] neg_lo:[0,1,0] neg_hi:[0,1,0]
    v_pk_mul_f32 v[180:181], v[180:181], v[188:189]
    v_pk_mul_f32 v[180:181], v[180:181], v[18:19] op_sel:[0,1] op_sel_hi:[1,1]
    v_cvt_pk_bf16_f32 v38, v180, v181
    v_pk_fma_f32 v[182:183], v[118:119], v[18:19], v[182:183] op_sel:[0,0,0] op_sel_hi:[1,0,1] neg_lo:[0,1,0] neg_hi:[0,1,0]
    v_pk_fma_f32 v[190:191], v[126:127], v[18:19], v[190:191] op_sel:[0,0,0] op_sel_hi:[1,0,1] neg_lo:[0,1,0] neg_hi:[0,1,0]
    v_pk_mul_f32 v[182:183], v[182:183], v[190:191]
    v_pk_mul_f32 v[182:183], v[182:183], v[18:19] op_sel:[0,1] op_sel_hi:[1,1]
    v_cvt_pk_bf16_f32 v39, v182, v183
    s_add_u32 s35, s30, 172032
    buffer_store_dwordx4 v[36:39], v5, s[16:19], s35 offen sc0 sc1
    v_mul_f32 v21, v21, v21
    v_pk_fma_f32 v[192:193], v[112:113], v[20:21], v[192:193] op_sel:[0,0,0] op_sel_hi:[1,0,1] neg_lo:[0,1,0] neg_hi:[0,1,0]
    v_pk_fma_f32 v[200:201], v[120:121], v[20:21], v[200:201] op_sel:[0,0,0] op_sel_hi:[1,0,1] neg_lo:[0,1,0] neg_hi:[0,1,0]
    v_pk_mul_f32 v[192:193], v[192:193], v[200:201]
    v_pk_mul_f32 v[192:193], v[192:193], v[20:21] op_sel:[0,1] op_sel_hi:[1,1]
    v_cvt_pk_bf16_f32 v32, v192, v193
    v_pk_fma_f32 v[194:195], v[114:115], v[20:21], v[194:195] op_sel:[0,0,0] op_sel_hi:[1,0,1] neg_lo:[0,1,0] neg_hi:[0,1,0]
    v_pk_fma_f32 v[202:203], v[122:123], v[20:21], v[202:203] op_sel:[0,0,0] op_sel_hi:[1,0,1] neg_lo:[0,1,0] neg_hi:[0,1,0]
    v_pk_mul_f32 v[194:195], v[194:195], v[202:203]
    v_pk_mul_f32 v[194:195], v[194:195], v[20:21] op_sel:[0,1] op_sel_hi:[1,1]
    v_cvt_pk_bf16_f32 v33, v194, v195
    v_pk_fma_f32 v[196:197], v[116:117], v[20:21], v[196:197] op_sel:[0,0,0] op_sel_hi:[1,0,1] neg_lo:[0,1,0] neg_hi:[0,1,0]
    v_pk_fma_f32 v[204:205], v[124:125], v[20:21], v[204:205] op_sel:[0,0,0] op_sel_hi:[1,0,1] neg_lo:[0,1,0] neg_hi:[0,1,0]
    v_pk_mul_f32 v[196:197], v[196:197], v[204:205]
    v_pk_mul_f32 v[196:197], v[196:197], v[20:21] op_sel:[0,1] op_sel_hi:[1,1]
    v_cvt_pk_bf16_f32 v34, v196, v197
    v_pk_fma_f32 v[198:199], v[118:119], v[20:21], v[198:199] op_sel:[0,0,0] op_sel_hi:[1,0,1] neg_lo:[0,1,0] neg_hi:[0,1,0]
    v_pk_fma_f32 v[206:207], v[126:127], v[20:21], v[206:207] op_sel:[0,0,0] op_sel_hi:[1,0,1] neg_lo:[0,1,0] neg_hi:[0,1,0]
    v_pk_mul_f32 v[198:199], v[198:199], v[206:207]
    v_pk_mul_f32 v[198:199], v[198:199], v[20:21] op_sel:[0,1] op_sel_hi:[1,1]
    v_cvt_pk_bf16_f32 v35, v198, v199
    s_add_u32 s35, s30, 229376
    buffer_store_dwordx4 v[32:35], v5, s[16:19], s35 offen sc0 sc1
    v_mul_f32 v23, v23, v23
    v_pk_fma_f32 v[208:209], v[112:113], v[22:23], v[208:209] op_sel:[0,0,0] op_sel_hi:[1,0,1] neg_lo:[0,1,0] neg_hi:[0,1,0]
    v_pk_fma_f32 v[216:217], v[120:121], v[22:23], v[216:217] op_sel:[0,0,0] op_sel_hi:[1,0,1] neg_lo:[0,1,0] neg_hi:[0,1,0]
    v_pk_mul_f32 v[208:209], v[208:209], v[216:217]
    v_pk_mul_f32 v[208:209], v[208:209], v[22:23] op_sel:[0,1] op_sel_hi:[1,1]
    v_cvt_pk_bf16_f32 v36, v208, v209
    v_pk_fma_f32 v[210:211], v[114:115], v[22:23], v[210:211] op_sel:[0,0,0] op_sel_hi:[1,0,1] neg_lo:[0,1,0] neg_hi:[0,1,0]
    v_pk_fma_f32 v[218:219], v[122:123], v[22:23], v[218:219] op_sel:[0,0,0] op_sel_hi:[1,0,1] neg_lo:[0,1,0] neg_hi:[0,1,0]
    v_pk_mul_f32 v[210:211], v[210:211], v[218:219]
    v_pk_mul_f32 v[210:211], v[210:211], v[22:23] op_sel:[0,1] op_sel_hi:[1,1]
    v_cvt_pk_bf16_f32 v37, v210, v211
    v_pk_fma_f32 v[212:213], v[116:117], v[22:23], v[212:213] op_sel:[0,0,0] op_sel_hi:[1,0,1] neg_lo:[0,1,0] neg_hi:[0,1,0]
    v_pk_fma_f32 v[220:221], v[124:125], v[22:23], v[220:221] op_sel:[0,0,0] op_sel_hi:[1,0,1] neg_lo:[0,1,0] neg_hi:[0,1,0]
    v_pk_mul_f32 v[212:213], v[212:213], v[220:221]
    v_pk_mul_f32 v[212:213], v[212:213], v[22:23] op_sel:[0,1] op_sel_hi:[1,1]
    v_cvt_pk_bf16_f32 v38, v212, v213
    v_pk_fma_f32 v[214:215], v[118:119], v[22:23], v[214:215] op_sel:[0,0,0] op_sel_hi:[1,0,1] neg_lo:[0,1,0] neg_hi:[0,1,0]
    v_pk_fma_f32 v[222:223], v[126:127], v[22:23], v[222:223] op_sel:[0,0,0] op_sel_hi:[1,0,1] neg_lo:[0,1,0] neg_hi:[0,1,0]
    v_pk_mul_f32 v[214:215], v[214:215], v[222:223]
    v_pk_mul_f32 v[214:215], v[214:215], v[22:23] op_sel:[0,1] op_sel_hi:[1,1]
    v_cvt_pk_bf16_f32 v39, v214, v215
    s_add_u32 s35, s30, 286720
    buffer_store_dwordx4 v[36:39], v5, s[16:19], s35 offen sc0 sc1
    v_mul_f32 v25, v25, v25
    v_pk_fma_f32 v[224:225], v[112:113], v[24:25], v[224:225] op_sel:[0,0,0] op_sel_hi:[1,0,1] neg_lo:[0,1,0] neg_hi:[0,1,0]
    v_pk_fma_f32 v[232:233], v[120:121], v[24:25], v[232:233] op_sel:[0,0,0] op_sel_hi:[1,0,1] neg_lo:[0,1,0] neg_hi:[0,1,0]
    v_pk_mul_f32 v[224:225], v[224:225], v[232:233]
    v_pk_mul_f32 v[224:225], v[224:225], v[24:25] op_sel:[0,1] op_sel_hi:[1,1]
    v_cvt_pk_bf16_f32 v32, v224, v225
    v_pk_fma_f32 v[226:227], v[114:115], v[24:25], v[226:227] op_sel:[0,0,0] op_sel_hi:[1,0,1] neg_lo:[0,1,0] neg_hi:[0,1,0]
    v_pk_fma_f32 v[234:235], v[122:123], v[24:25], v[234:235] op_sel:[0,0,0] op_sel_hi:[1,0,1] neg_lo:[0,1,0] neg_hi:[0,1,0]
    v_pk_mul_f32 v[226:227], v[226:227], v[234:235]
    v_pk_mul_f32 v[226:227], v[226:227], v[24:25] op_sel:[0,1] op_sel_hi:[1,1]
    v_cvt_pk_bf16_f32 v33, v226, v227
    v_pk_fma_f32 v[228:229], v[116:117], v[24:25], v[228:229] op_sel:[0,0,0] op_sel_hi:[1,0,1] neg_lo:[0,1,0] neg_hi:[0,1,0]
    v_pk_fma_f32 v[236:237], v[124:125], v[24:25], v[236:237] op_sel:[0,0,0] op_sel_hi:[1,0,1] neg_lo:[0,1,0] neg_hi:[0,1,0]
    v_pk_mul_f32 v[228:229], v[228:229], v[236:237]
    v_pk_mul_f32 v[228:229], v[228:229], v[24:25] op_sel:[0,1] op_sel_hi:[1,1]
    v_cvt_pk_bf16_f32 v34, v228, v229
    v_pk_fma_f32 v[230:231], v[118:119], v[24:25], v[230:231] op_sel:[0,0,0] op_sel_hi:[1,0,1] neg_lo:[0,1,0] neg_hi:[0,1,0]
    v_pk_fma_f32 v[238:239], v[126:127], v[24:25], v[238:239] op_sel:[0,0,0] op_sel_hi:[1,0,1] neg_lo:[0,1,0] neg_hi:[0,1,0]
    v_pk_mul_f32 v[230:231], v[230:231], v[238:239]
    v_pk_mul_f32 v[230:231], v[230:231], v[24:25] op_sel:[0,1] op_sel_hi:[1,1]
    v_cvt_pk_bf16_f32 v35, v230, v231
    s_add_u32 s35, s30, 344064
    buffer_store_dwordx4 v[32:35], v5, s[16:19], s35 offen sc0 sc1
    v_mul_f32 v27, v27, v27
    v_pk_fma_f32 v[240:241], v[112:113], v[26:27], v[240:241] op_sel:[0,0,0] op_sel_hi:[1,0,1] neg_lo:[0,1,0] neg_hi:[0,1,0]
    v_pk_fma_f32 v[248:249], v[120:121], v[26:27], v[248:249] op_sel:[0,0,0] op_sel_hi:[1,0,1] neg_lo:[0,1,0] neg_hi:[0,1,0]
    v_pk_mul_f32 v[240:241], v[240:241], v[248:249]
    v_pk_mul_f32 v[240:241], v[240:241], v[26:27] op_sel:[0,1] op_sel_hi:[1,1]
    v_cvt_pk_bf16_f32 v36, v240, v241
    v_pk_fma_f32 v[242:243], v[114:115], v[26:27], v[242:243] op_sel:[0,0,0] op_sel_hi:[1,0,1] neg_lo:[0,1,0] neg_hi:[0,1,0]
    v_pk_fma_f32 v[250:251], v[122:123], v[26:27], v[250:251] op_sel:[0,0,0] op_sel_hi:[1,0,1] neg_lo:[0,1,0] neg_hi:[0,1,0]
    v_pk_mul_f32 v[242:243], v[242:243], v[250:251]
    v_pk_mul_f32 v[242:243], v[242:243], v[26:27] op_sel:[0,1] op_sel_hi:[1,1]
    v_cvt_pk_bf16_f32 v37, v242, v243
    v_pk_fma_f32 v[244:245], v[116:117], v[26:27], v[244:245] op_sel:[0,0,0] op_sel_hi:[1,0,1] neg_lo:[0,1,0] neg_hi:[0,1,0]
    v_pk_fma_f32 v[252:253], v[124:125], v[26:27], v[252:253] op_sel:[0,0,0] op_sel_hi:[1,0,1] neg_lo:[0,1,0] neg_hi:[0,1,0]
    v_pk_mul_f32 v[244:245], v[244:245], v[252:253]
    v_pk_mul_f32 v[244:245], v[244:245], v[26:27] op_sel:[0,1] op_sel_hi:[1,1]
    v_cvt_pk_bf16_f32 v38, v244, v245
    v_pk_fma_f32 v[246:247], v[118:119], v[26:27], v[246:247] op_sel:[0,0,0] op_sel_hi:[1,0,1] neg_lo:[0,1,0] neg_hi:[0,1,0]
    v_pk_fma_f32 v[254:255], v[126:127], v[26:27], v[254:255] op_sel:[0,0,0] op_sel_hi:[1,0,1] neg_lo:[0,1,0] neg_hi:[0,1,0]
    v_pk_mul_f32 v[246:247], v[246:247], v[254:255]
    v_pk_mul_f32 v[246:247], v[246:247], v[26:27] op_sel:[0,1] op_sel_hi:[1,1]
    v_cvt_pk_bf16_f32 v39, v246, v247
    s_add_u32 s35, s30, 401408
    buffer_store_dwordx4 v[36:39], v5, s[16:19], s35 offen sc0 sc1
    s_waitcnt vmcnt(0)
    s_barrier
    s_cmp_lg_u32 s3, 0
    s_cbranch_scc1 ffn_kernel_s210
    s_add_u32 s28, s42, 4096
    v_mov_b32 v11, s28
    v_mov_b32 v4, 1
    s_mov_b64 s[44:45], exec
    s_mov_b64 exec, 1
    buffer_atomic_add v4, v11, s[84:87], 0 offen sc1
    s_mov_b32 s29, 0
ffn_kernel_s211:
    buffer_load_dword v4, v11, s[84:87], 0 offen sc0 sc1
    s_waitcnt vmcnt(0)
    v_readfirstlane_b32 s30, v4
    s_add_u32 s29, s29, 1
    s_cmp_ge_u32 s30, 14
    s_cbranch_scc1 ffn_kernel_s212
    s_cmp_ge_u32 s29, 0x40000
    s_cbranch_scc1 ffn_kernel_s212
    s_sleep 1
    s_branch ffn_kernel_s211
ffn_kernel_s212:
    s_mov_b64 exec, s[44:45]
ffn_kernel_s210:
    s_add_u32 s28, s41, 12288
    buffer_load_dwordx4 a[208:211], v5, s[12:15], s28 offen offset:1024
    s_add_u32 s28, s41, 69632
    buffer_load_dwordx4 a[212:215], v5, s[12:15], s28 offen offset:1024
    s_add_u32 s28, s41, 126976
    buffer_load_dwordx4 a[216:219], v5, s[12:15], s28 offen offset:1024
    s_add_u32 s28, s41, 184320
    buffer_load_dwordx4 a[220:223], v5, s[12:15], s28 offen offset:1024
    s_barrier
    s_add_u32 s28, s40, 0
    buffer_load_dwordx4 v[128:131], v5, s[16:19], s28 offen offset:0 sc0 sc1
    s_add_u32 s28, s40, 57344
    buffer_load_dwordx4 v[132:135], v5, s[16:19], s28 offen offset:0 sc0 sc1
    s_add_u32 s28, s40, 114688
    buffer_load_dwordx4 v[136:139], v5, s[16:19], s28 offen offset:0 sc0 sc1
    s_add_u32 s28, s40, 172032
    buffer_load_dwordx4 v[140:143], v5, s[16:19], s28 offen offset:0 sc0 sc1
    s_add_u32 s28, s40, 0
    buffer_load_dwordx4 v[144:147], v5, s[16:19], s28 offen offset:1024 sc0 sc1
    s_add_u32 s28, s40, 57344
    buffer_load_dwordx4 v[148:151], v5, s[16:19], s28 offen offset:1024 sc0 sc1
    s_add_u32 s28, s40, 114688
    buffer_load_dwordx4 v[152:155], v5, s[16:19], s28 offen offset:1024 sc0 sc1
    s_add_u32 s28, s40, 172032
    buffer_load_dwordx4 v[156:159], v5, s[16:19], s28 offen offset:1024 sc0 sc1
    s_add_u32 s28, s40, 0
    buffer_load_dwordx4 v[160:163], v5, s[16:19], s28 offen offset:2048 sc0 sc1
    s_add_u32 s28, s40, 57344
    buffer_load_dwordx4 v[164:167], v5, s[16:19], s28 offen offset:2048 sc0 sc1
    s_add_u32 s28, s40, 114688
    buffer_load_dwordx4 v[168:171], v5, s[16:19], s28 offen offset:2048 sc0 sc1
    s_add_u32 s28, s40, 172032
    buffer_load_dwordx4 v[172:175], v5, s[16:19], s28 offen offset:2048 sc0 sc1
    s_add_u32 s28, s40, 0
    buffer_load_dwordx4 v[176:179], v5, s[16:19], s28 offen offset:3072 sc0 sc1
    s_add_u32 s28, s40, 57344
    buffer_load_dwordx4 v[180:183], v5, s[16:19], s28 offen offset:3072 sc0 sc1
    s_add_u32 s28, s40, 114688
    buffer_load_dwordx4 v[184:187], v5, s[16:19], s28 offen offset:3072 sc0 sc1
    s_add_u32 s28, s40, 172032
    buffer_load_dwordx4 v[188:191], v5, s[16:19], s28 offen offset:3072 sc0 sc1
    s_add_u32 s28, s40, 4096
    buffer_load_dwordx4 v[192:195], v5, s[16:19], s28 offen offset:0 sc0 sc1
    s_add_u32 s28, s40, 61440
    buffer_load_dwordx4 v[196:199], v5, s[16:19], s28 offen offset:0 sc0 sc1
    s_add_u32 s28, s40, 118784
    buffer_load_dwordx4 v[200:203], v5, s[16:19], s28 offen offset:0 sc0 sc1
    s_add_u32 s28, s40, 176128
    buffer_load_dwordx4 v[204:207], v5, s[16:19], s28 offen offset:0 sc0 sc1
    s_add_u32 s28, s40, 4096
    buffer_load_dwordx4 v[208:211], v5, s[16:19], s28 offen offset:1024 sc0 sc1
    s_add_u32 s28, s40, 61440
    buffer_load_dwordx4 v[212:215], v5, s[16:19], s28 offen offset:1024 sc0 sc1
    s_add_u32 s28, s40, 118784
    buffer_load_dwordx4 v[216:219], v5, s[16:19], s28 offen offset:1024 sc0 sc1
    s_add_u32 s28, s40, 176128
    buffer_load_dwordx4 v[220:223], v5, s[16:19], s28 offen offset:1024 sc0 sc1
    s_add_u32 s28, s40, 4096
    buffer_load_dwordx4 v[224:227], v5, s[16:19], s28 offen offset:2048 sc0 sc1
    s_add_u32 s28, s40, 61440
    buffer_load_dwordx4 v[228:231], v5, s[16:19], s28 offen offset:2048 sc0 sc1
    s_add_u32 s28, s40, 118784
    buffer_load_dwordx4 v[232:235], v5, s[16:19], s28 offen offset:2048 sc0 sc1
    s_add_u32 s28, s40, 176128
    buffer_load_dwordx4 v[236:239], v5, s[16:19], s28 offen offset:2048 sc0 sc1
    s_add_u32 s28, s40, 4096
    buffer_load_dwordx4 v[240:243], v5, s[16:19], s28 offen offset:3072 sc0 sc1
    s_add_u32 s28, s40, 61440
    buffer_load_dwordx4 v[244:247], v5, s[16:19], s28 offen offset:3072 sc0 sc1
    s_add_u32 s28, s40, 118784
    buffer_load_dwordx4 v[248:251], v5, s[16:19], s28 offen offset:3072 sc0 sc1
    s_add_u32 s28, s40, 176128
    buffer_load_dwordx4 v[252:255], v5, s[16:19], s28 offen offset:3072 sc0 sc1
    s_waitcnt vmcnt(28)
    v_mfma_f32_16x16x32_bf16 v[12:15], a[0:3], v[128:131], 0
    v_mfma_f32_16x16x32_bf16 v[16:19], a[0:3], v[132:135], 0
    v_mfma_f32_16x16x32_bf16 v[20:23], a[0:3], v[136:139], 0
    v_mfma_f32_16x16x32_bf16 v[24:27], a[0:3], v[140:143], 0
    v_mfma_f32_16x16x32_bf16 v[28:31], a[4:7], v[128:131], 0
    v_mfma_f32_16x16x32_bf16 v[32:35], a[4:7], v[132:135], 0
    v_mfma_f32_16x16x32_bf16 v[36:39], a[4:7], v[136:139], 0
    v_mfma_f32_16x16x32_bf16 v[40:43], a[4:7], v[140:143], 0
    v_mfma_f32_16x16x32_bf16 v[44:47], a[8:11], v[128:131], 0
    v_mfma_f32_16x16x32_bf16 v[48:51], a[8:11], v[132:135], 0
    v_mfma_f32_16x16x32_bf16 v[52:55], a[8:11], v[136:139], 0
    v_mfma_f32_16x16x32_bf16 v[56:59], a[8:11], v[140:143], 0
    v_mfma_f32_16x16x32_bf16 v[60:63], a[12:15], v[128:131], 0
    v_mfma_f32_16x16x32_bf16 v[64:67], a[12:15], v[132:135], 0
    v_mfma_f32_16x16x32_bf16 v[68:71], a[12:15], v[136:139], 0
    v_mfma_f32_16x16x32_bf16 v[72:75], a[12:15], v[140:143], 0
    s_add_u32 s28, s40, 8192
    buffer_load_dwordx4 v[128:131], v5, s[16:19], s28 offen offset:0 sc0 sc1
    s_add_u32 s28, s40, 65536
    buffer_load_dwordx4 v[132:135], v5, s[16:19], s28 offen offset:0 sc0 sc1
    s_add_u32 s28, s40, 122880
    buffer_load_dwordx4 v[136:139], v5, s[16:19], s28 offen offset:0 sc0 sc1
    s_add_u32 s28, s40, 180224
    buffer_load_dwordx4 v[140:143], v5, s[16:19], s28 offen offset:0 sc0 sc1
    s_waitcnt vmcnt(28)
    v_mfma_f32_16x16x32_bf16 v[12:15], a[16:19], v[144:147], v[12:15]
    v_mfma_f32_16x16x32_bf16 v[16:19], a[16:19], v[148:151], v[16:19]
    v_mfma_f32_16x16x32_bf16 v[20:23], a[16:19], v[152:155], v[20:23]
    v_mfma_f32_16x16x32_bf16 v[24:27], a[16:19], v[156:159], v[24:27]
    v_mfma_f32_16x16x32_bf16 v[28:31], a[20:23], v[144:147], v[28:31]
    v_mfma_f32_16x16x32_bf16 v[32:35], a[20:23], v[148:151], v[32:35]
    v_mfma_f32_16x16x32_bf16 v[36:39], a[20:23], v[152:155], v[36:39]
    v_mfma_f32_16x16x32_bf16 v[40:43], a[20:23], v[156:159], v[40:43]
    v_mfma_f32_16x16x32_bf16 v[44:47], a[24:27], v[144:147], v[44:47]
    v_mfma_f32_16x16x32_bf16 v[48:51], a[24:27], v[148:151], v[48:51]
    v_mfma_f32_16x16x32_bf16 v[52:55], a[24:27], v[152:155], v[52:55]
    v_mfma_f32_16x16x32_bf16 v[56:59], a[24:27], v[156:159], v[56:59]
    v_mfma_f32_16x16x32_bf16 v[60:63], a[28:31], v[144:147], v[60:63]
    v_mfma_f32_16x16x32_bf16 v[64:67], a[28:31], v[148:151], v[64:67]
    v_mfma_f32_16x16x32_bf16 v[68:71], a[28:31], v[152:155], v[68:71]
    v_mfma_f32_16x16x32_bf16 v[72:75], a[28:31], v[156:159], v[72:75]
    s_add_u32 s28, s40, 8192
    buffer_load_dwordx4 v[144:147], v5, s[16:19], s28 offen offset:1024 sc0 sc1
    s_add_u32 s28, s40, 65536
    buffer_load_dwordx4 v[148:151], v5, s[16:19], s28 offen offset:1024 sc0 sc1
    s_add_u32 s28, s40, 122880
    buffer_load_dwordx4 v[152:155], v5, s[16:19], s28 offen offset:1024 sc0 sc1
    s_add_u32 s28, s40, 180224
    buffer_load_dwordx4 v[156:159], v5, s[16:19], s28 offen offset:1024 sc0 sc1
    s_waitcnt vmcnt(28)
    v_mfma_f32_16x16x32_bf16 v[12:15], a[32:35], v[160:163], v[12:15]
    v_mfma_f32_16x16x32_bf16 v[16:19], a[32:35], v[164:167], v[16:19]
    v_mfma_f32_16x16x32_bf16 v[20:23], a[32:35], v[168:171], v[20:23]
    v_mfma_f32_16x16x32_bf16 v[24:27], a[32:35], v[172:175], v[24:27]
    v_mfma_f32_16x16x32_bf16 v[28:31], a[36:39], v[160:163], v[28:31]
    v_mfma_f32_16x16x32_bf16 v[32:35], a[36:39], v[164:167], v[32:35]
    v_mfma_f32_16x16x32_bf16 v[36:39], a[36:39], v[168:171], v[36:39]
    v_mfma_f32_16x16x32_bf16 v[40:43], a[36:39], v[172:175], v[40:43]
    v_mfma_f32_16x16x32_bf16 v[44:47], a[40:43], v[160:163], v[44:47]
    v_mfma_f32_16x16x32_bf16 v[48:51], a[40:43], v[164:167], v[48:51]
    v_mfma_f32_16x16x32_bf16 v[52:55], a[40:43], v[168:171], v[52:55]
    v_mfma_f32_16x16x32_bf16 v[56:59], a[40:43], v[172:175], v[56:59]
    v_mfma_f32_16x16x32_bf16 v[60:63], a[44:47], v[160:163], v[60:63]
    v_mfma_f32_16x16x32_bf16 v[64:67], a[44:47], v[164:167], v[64:67]
    v_mfma_f32_16x16x32_bf16 v[68:71], a[44:47], v[168:171], v[68:71]
    v_mfma_f32_16x16x32_bf16 v[72:75], a[44:47], v[172:175], v[72:75]
    s_add_u32 s28, s40, 8192
    buffer_load_dwordx4 v[160:163], v5, s[16:19], s28 offen offset:2048 sc0 sc1
    s_add_u32 s28, s40, 65536
    buffer_load_dwordx4 v[164:167], v5, s[16:19], s28 offen offset:2048 sc0 sc1
    s_add_u32 s28, s40, 122880
    buffer_load_dwordx4 v[168:171], v5, s[16:19], s28 offen offset:2048 sc0 sc1
    s_add_u32 s28, s40, 180224
    buffer_load_dwordx4 v[172:175], v5, s[16:19], s28 offen offset:2048 sc0 sc1
    s_waitcnt vmcnt(28)
    v_mfma_f32_16x16x32_bf16 v[12:15], a[48:51], v[176:179], v[12:15]
    v_mfma_f32_16x16x32_bf16 v[16:19], a[48:51], v[180:183], v[16:19]
    v_mfma_f32_16x16x32_bf16 v[20:23], a[48:51], v[184:187], v[20:23]
    v_mfma_f32_16x16x32_bf16 v[24:27], a[48:51], v[188:191], v[24:27]
    v_mfma_f32_16x16x32_bf16 v[28:31], a[52:55], v[176:179], v[28:31]
    v_mfma_f32_16x16x32_bf16 v[32:35], a[52:55], v[180:183], v[32:35]
    v_mfma_f32_16x16x32_bf16 v[36:39], a[52:55], v[184:187], v[36:39]
    v_mfma_f32_16x16x32_bf16 v[40:43], a[52:55], v[188:191], v[40:43]
    v_mfma_f32_16x16x32_bf16 v[44:47], a[56:59], v[176:179], v[44:47]
    v_mfma_f32_16x16x32_bf16 v[48:51], a[56:59], v[180:183], v[48:51]
    v_mfma_f32_16x16x32_bf16 v[52:55], a[56:59], v[184:187], v[52:55]
    v_mfma_f32_16x16x32_bf16 v[56:59], a[56:59], v[188:191], v[56:59]
    v_mfma_f32_16x16x32_bf16 v[60:63], a[60:63], v[176:179], v[60:63]
    v_mfma_f32_16x16x32_bf16 v[64:67], a[60:63], v[180:183], v[64:67]
    v_mfma_f32_16x16x32_bf16 v[68:71], a[60:63], v[184:187], v[68:71]
    v_mfma_f32_16x16x32_bf16 v[72:75], a[60:63], v[188:191], v[72:75]
    s_add_u32 s28, s40, 8192
    buffer_load_dwordx4 v[176:179], v5, s[16:19], s28 offen offset:3072 sc0 sc1
    s_add_u32 s28, s40, 65536
    buffer_load_dwordx4 v[180:183], v5, s[16:19], s28 offen offset:3072 sc0 sc1
    s_add_u32 s28, s40, 122880
    buffer_load_dwordx4 v[184:187], v5, s[16:19], s28 offen offset:3072 sc0 sc1
    s_add_u32 s28, s40, 180224
    buffer_load_dwordx4 v[188:191], v5, s[16:19], s28 offen offset:3072 sc0 sc1
    s_waitcnt vmcnt(28)
    v_mfma_f32_16x16x32_bf16 v[12:15], a[64:67], v[192:195], v[12:15]
    v_mfma_f32_16x16x32_bf16 v[16:19], a[64:67], v[196:199], v[16:19]
    v_mfma_f32_16x16x32_bf16 v[20:23], a[64:67], v[200:203], v[20:23]
    v_mfma_f32_16x16x32_bf16 v[24:27], a[64:67], v[204:207], v[24:27]
    v_mfma_f32_16x16x32_bf16 v[28:31], a[68:71], v[192:195], v[28:31]
    v_mfma_f32_16x16x32_bf16 v[32:35], a[68:71], v[196:199], v[32:35]
    v_mfma_f32_16x16x32_bf16 v[36:39], a[68:71], v[200:203], v[36:39]
    v_mfma_f32_16x16x32_bf16 v[40:43], a[68:71], v[204:207], v[40:43]
    v_mfma_f32_16x16x32_bf16 v[44:47], a[72:75], v[192:195], v[44:47]
    v_mfma_f32_16x16x32_bf16 v[48:51], a[72:75], v[196:199], v[48:51]
    v_mfma_f32_16x16x32_bf16 v[52:55], a[72:75], v[200:203], v[52:55]
    v_mfma_f32_16x16x32_bf16 v[56:59], a[72:75], v[204:207], v[56:59]
    v_mfma_f32_16x16x32_bf16 v[60:63], a[76:79], v[192:195], v[60:63]
    v_mfma_f32_16x16x32_bf16 v[64:67], a[76:79], v[196:199], v[64:67]
    v_mfma_f32_16x16x32_bf16 v[68:71], a[76:79], v[200:203], v[68:71]
    v_mfma_f32_16x16x32_bf16 v[72:75], a[76:79], v[204:207], v[72:75]
    s_add_u32 s28, s40, 12288
    buffer_load_dwordx4 v[192:195], v5, s[16:19], s28 offen offset:0 sc0 sc1
    s_add_u32 s28, s40, 69632
    buffer_load_dwordx4 v[196:199], v5, s[16:19], s28 offen offset:0 sc0 sc1
    s_add_u32 s28, s40, 126976
    buffer_load_dwordx4 v[200:203], v5, s[16:19], s28 offen offset:0 sc0 sc1
    s_add_u32 s28, s40, 184320
    buffer_load_dwordx4 v[204:207], v5, s[16:19], s28 offen offset:0 sc0 sc1
    s_waitcnt vmcnt(28)
    v_mfma_f32_16x16x32_bf16 v[12:15], a[80:83], v[208:211], v[12:15]
    v_mfma_f32_16x16x32_bf16 v[16:19], a[80:83], v[212:215], v[16:19]
    v_mfma_f32_16x16x32_bf16 v[20:23], a[80:83], v[216:219], v[20:23]
    v_mfma_f32_16x16x32_bf16 v[24:27], a[80:83], v[220:223], v[24:27]
    v_mfma_f32_16x16x32_bf16 v[28:31], a[84:87], v[208:211], v[28:31]
    v_mfma_f32_16x16x32_bf16 v[32:35], a[84:87], v[212:215], v[32:35]
    v_mfma_f32_16x16x32_bf16 v[36:39], a[84:87], v[216:219], v[36:39]
    v_mfma_f32_16x16x32_bf16 v[40:43], a[84:87], v[220:223], v[40:43]
    v_mfma_f32_16x16x32_bf16 v[44:47], a[88:91], v[208:211], v[44:47]
    v_mfma_f32_16x16x32_bf16 v[48:51], a[88:91], v[212:215], v[48:51]
    v_mfma_f32_16x16x32_bf16 v[52:55], a[88:91], v[216:219], v[52:55]
    v_mfma_f32_16x16x32_bf16 v[56:59], a[88:91], v[220:223], v[56:59]
    v_mfma_f32_16x16x32_bf16 v[60:63], a[92:95], v[208:211], v[60:63]
    v_mfma_f32_16x16x32_bf16 v[64:67], a[92:95], v[212:215], v[64:67]
    v_mfma_f32_16x16x32_bf16 v[68:71], a[92:95], v[216:219], v[68:71]
    v_mfma_f32_16x16x32_bf16 v[72:75], a[92:95], v[220:223], v[72:75]
    s_add_u32 s28, s40, 12288
    buffer_load_dwordx4 v[208:211], v5, s[16:19], s28 offen offset:1024 sc0 sc1
    s_add_u32 s28, s40, 69632
    buffer_load_dwordx4 v[212:215], v5, s[16:19], s28 offen offset:1024 sc0 sc1
    s_add_u32 s28, s40, 126976
    buffer_load_dwordx4 v[216:219], v5, s[16:19], s28 offen offset:1024 sc0 sc1
    s_add_u32 s28, s40, 184320
    buffer_load_dwordx4 v[220:223], v5, s[16:19], s28 offen offset:1024 sc0 sc1
    s_waitcnt vmcnt(28)
    v_mfma_f32_16x16x32_bf16 v[12:15], a[96:99], v[224:227], v[12:15]
    v_mfma_f32_16x16x32_bf16 v[16:19], a[96:99], v[228:231], v[16:19]
    v_mfma_f32_16x16x32_bf16 v[20:23], a[96:99], v[232:235], v[20:23]
    v_mfma_f32_16x16x32_bf16 v[24:27], a[96:99], v[236:239], v[24:27]
    v_mfma_f32_16x16x32_bf16 v[28:31], a[100:103], v[224:227], v[28:31]
    v_mfma_f32_16x16x32_bf16 v[32:35], a[100:103], v[228:231], v[32:35]
    v_mfma_f32_16x16x32_bf16 v[36:39], a[100:103], v[232:235], v[36:39]
    v_mfma_f32_16x16x32_bf16 v[40:43], a[100:103], v[236:239], v[40:43]
    v_mfma_f32_16x16x32_bf16 v[44:47], a[104:107], v[224:227], v[44:47]
    v_mfma_f32_16x16x32_bf16 v[48:51], a[104:107], v[228:231], v[48:51]
    v_mfma_f32_16x16x32_bf16 v[52:55], a[104:107], v[232:235], v[52:55]
    v_mfma_f32_16x16x32_bf16 v[56:59], a[104:107], v[236:239], v[56:59]
    v_mfma_f32_16x16x32_bf16 v[60:63], a[108:111], v[224:227], v[60:63]
    v_mfma_f32_16x16x32_bf16 v[64:67], a[108:111], v[228:231], v[64:67]
    v_mfma_f32_16x16x32_bf16 v[68:71], a[108:111], v[232:235], v[68:71]
    v_mfma_f32_16x16x32_bf16 v[72:75], a[108:111], v[236:239], v[72:75]
    s_waitcnt vmcnt(24)
    v_mfma_f32_16x16x32_bf16 v[12:15], a[112:115], v[240:243], v[12:15]
    v_mfma_f32_16x16x32_bf16 v[16:19], a[112:115], v[244:247], v[16:19]
    v_mfma_f32_16x16x32_bf16 v[20:23], a[112:115], v[248:251], v[20:23]
    v_mfma_f32_16x16x32_bf16 v[24:27], a[112:115], v[252:255], v[24:27]
    v_mfma_f32_16x16x32_bf16 v[28:31], a[116:119], v[240:243], v[28:31]
    v_mfma_f32_16x16x32_bf16 v[32:35], a[116:119], v[244:247], v[32:35]
    v_mfma_f32_16x16x32_bf16 v[36:39], a[116:119], v[248:251], v[36:39]
    v_mfma_f32_16x16x32_bf16 v[40:43], a[116:119], v[252:255], v[40:43]
    v_mfma_f32_16x16x32_bf16 v[44:47], a[120:123], v[240:243], v[44:47]
    v_mfma_f32_16x16x32_bf16 v[48:51], a[120:123], v[244:247], v[48:51]
    v_mfma_f32_16x16x32_bf16 v[52:55], a[120:123], v[248:251], v[52:55]
    v_mfma_f32_16x16x32_bf16 v[56:59], a[120:123], v[252:255], v[56:59]
    v_mfma_f32_16x16x32_bf16 v[60:63], a[124:127], v[240:243], v[60:63]
    v_mfma_f32_16x16x32_bf16 v[64:67], a[124:127], v[244:247], v[64:67]
    v_mfma_f32_16x16x32_bf16 v[68:71], a[124:127], v[248:251], v[68:71]
    v_mfma_f32_16x16x32_bf16 v[72:75], a[124:127], v[252:255], v[72:75]
    s_waitcnt vmcnt(20)
    v_mfma_f32_16x16x32_bf16 v[12:15], a[128:131], v[128:131], v[12:15]
    v_mfma_f32_16x16x32_bf16 v[16:19], a[128:131], v[132:135], v[16:19]
    v_mfma_f32_16x16x32_bf16 v[20:23], a[128:131], v[136:139], v[20:23]
    v_mfma_f32_16x16x32_bf16 v[24:27], a[128:131], v[140:143], v[24:27]
    v_mfma_f32_16x16x32_bf16 v[28:31], a[132:135], v[128:131], v[28:31]
    v_mfma_f32_16x16x32_bf16 v[32:35], a[132:135], v[132:135], v[32:35]
    v_mfma_f32_16x16x32_bf16 v[36:39], a[132:135], v[136:139], v[36:39]
    v_mfma_f32_16x16x32_bf16 v[40:43], a[132:135], v[140:143], v[40:43]
    v_mfma_f32_16x16x32_bf16 v[44:47], a[136:139], v[128:131], v[44:47]
    v_mfma_f32_16x16x32_bf16 v[48:51], a[136:139], v[132:135], v[48:51]
    v_mfma_f32_16x16x32_bf16 v[52:55], a[136:139], v[136:139], v[52:55]
    v_mfma_f32_16x16x32_bf16 v[56:59], a[136:139], v[140:143], v[56:59]
    v_mfma_f32_16x16x32_bf16 v[60:63], a[140:143], v[128:131], v[60:63]
    v_mfma_f32_16x16x32_bf16 v[64:67], a[140:143], v[132:135], v[64:67]
    v_mfma_f32_16x16x32_bf16 v[68:71], a[140:143], v[136:139], v[68:71]
    v_mfma_f32_16x16x32_bf16 v[72:75], a[140:143], v[140:143], v[72:75]
    s_waitcnt vmcnt(16)
    v_mfma_f32_16x16x32_bf16 v[12:15], a[144:147], v[144:147], v[12:15]
    v_mfma_f32_16x16x32_bf16 v[16:19], a[144:147], v[148:151], v[16:19]
    v_mfma_f32_16x16x32_bf16 v[20:23], a[144:147], v[152:155], v[20:23]
    v_mfma_f32_16x16x32_bf16 v[24:27], a[144:147], v[156:159], v[24:27]
    v_mfma_f32_16x16x32_bf16 v[28:31], a[148:151], v[144:147], v[28:31]
    v_mfma_f32_16x16x32_bf16 v[32:35], a[148:151], v[148:151], v[32:35]
    v_mfma_f32_16x16x32_bf16 v[36:39], a[148:151], v[152:155], v[36:39]
    v_mfma_f32_16x16x32_bf16 v[40:43], a[148:151], v[156:159], v[40:43]
    v_mfma_f32_16x16x32_bf16 v[44:47], a[152:155], v[144:147], v[44:47]
    v_mfma_f32_16x16x32_bf16 v[48:51], a[152:155], v[148:151], v[48:51]
    v_mfma_f32_16x16x32_bf16 v[52:55], a[152:155], v[152:155], v[52:55]
    v_mfma_f32_16x16x32_bf16 v[56:59], a[152:155], v[156:159], v[56:59]
    v_mfma_f32_16x16x32_bf16 v[60:63], a[156:159], v[144:147], v[60:63]
    v_mfma_f32_16x16x32_bf16 v[64:67], a[156:159], v[148:151], v[64:67]
    v_mfma_f32_16x16x32_bf16 v[68:71], a[156:159], v[152:155], v[68:71]
    v_mfma_f32_16x16x32_bf16 v[72:75], a[156:159], v[156:159], v[72:75]
    s_waitcnt vmcnt(12)
    v_mfma_f32_16x16x32_bf16 v[12:15], a[160:163], v[160:163], v[12:15]
    v_mfma_f32_16x16x32_bf16 v[16:19], a[160:163], v[164:167], v[16:19]
    v_mfma_f32_16x16x32_bf16 v[20:23], a[160:163], v[168:171], v[20:23]
    v_mfma_f32_16x16x32_bf16 v[24:27], a[160:163], v[172:175], v[24:27]
    v_mfma_f32_16x16x32_bf16 v[28:31], a[164:167], v[160:163], v[28:31]
    v_mfma_f32_16x16x32_bf16 v[32:35], a[164:167], v[164:167], v[32:35]
    v_mfma_f32_16x16x32_bf16 v[36:39], a[164:167], v[168:171], v[36:39]
    v_mfma_f32_16x16x32_bf16 v[40:43], a[164:167], v[172:175], v[40:43]
    v_mfma_f32_16x16x32_bf16 v[44:47], a[168:171], v[160:163], v[44:47]
    v_mfma_f32_16x16x32_bf16 v[48:51], a[168:171], v[164:167], v[48:51]
    v_mfma_f32_16x16x32_bf16 v[52:55], a[168:171], v[168:171], v[52:55]
    v_mfma_f32_16x16x32_bf16 v[56:59], a[168:171], v[172:175], v[56:59]
    v_mfma_f32_16x16x32_bf16 v[60:63], a[172:175], v[160:163], v[60:63]
    v_mfma_f32_16x16x32_bf16 v[64:67], a[172:175], v[164:167], v[64:67]
    v_mfma_f32_16x16x32_bf16 v[68:71], a[172:175], v[168:171], v[68:71]
    v_mfma_f32_16x16x32_bf16 v[72:75], a[172:175], v[172:175], v[72:75]
    s_waitcnt vmcnt(8)
    v_mfma_f32_16x16x32_bf16 v[12:15], a[176:179], v[176:179], v[12:15]
    v_mfma_f32_16x16x32_bf16 v[16:19], a[176:179], v[180:183], v[16:19]
    v_mfma_f32_16x16x32_bf16 v[20:23], a[176:179], v[184:187], v[20:23]
    v_mfma_f32_16x16x32_bf16 v[24:27], a[176:179], v[188:191], v[24:27]
    v_mfma_f32_16x16x32_bf16 v[28:31], a[180:183], v[176:179], v[28:31]
    v_mfma_f32_16x16x32_bf16 v[32:35], a[180:183], v[180:183], v[32:35]
    v_mfma_f32_16x16x32_bf16 v[36:39], a[180:183], v[184:187], v[36:39]
    v_mfma_f32_16x16x32_bf16 v[40:43], a[180:183], v[188:191], v[40:43]
    v_mfma_f32_16x16x32_bf16 v[44:47], a[184:187], v[176:179], v[44:47]
    v_mfma_f32_16x16x32_bf16 v[48:51], a[184:187], v[180:183], v[48:51]
    v_mfma_f32_16x16x32_bf16 v[52:55], a[184:187], v[184:187], v[52:55]
    v_mfma_f32_16x16x32_bf16 v[56:59], a[184:187], v[188:191], v[56:59]
    v_mfma_f32_16x16x32_bf16 v[60:63], a[188:191], v[176:179], v[60:63]
    v_mfma_f32_16x16x32_bf16 v[64:67], a[188:191], v[180:183], v[64:67]
    v_mfma_f32_16x16x32_bf16 v[68:71], a[188:191], v[184:187], v[68:71]
    v_mfma_f32_16x16x32_bf16 v[72:75], a[188:191], v[188:191], v[72:75]
    s_waitcnt vmcnt(4)
    v_mfma_f32_16x16x32_bf16 v[12:15], a[192:195], v[192:195], v[12:15]
    v_mfma_f32_16x16x32_bf16 v[16:19], a[192:195], v[196:199], v[16:19]
    v_mfma_f32_16x16x32_bf16 v[20:23], a[192:195], v[200:203], v[20:23]
    v_mfma_f32_16x16x32_bf16 v[24:27], a[192:195], v[204:207], v[24:27]
    v_mfma_f32_16x16x32_bf16 v[28:31], a[196:199], v[192:195], v[28:31]
    v_mfma_f32_16x16x32_bf16 v[32:35], a[196:199], v[196:199], v[32:35]
    v_mfma_f32_16x16x32_bf16 v[36:39], a[196:199], v[200:203], v[36:39]
    v_mfma_f32_16x16x32_bf16 v[40:43], a[196:199], v[204:207], v[40:43]
    v_mfma_f32_16x16x32_bf16 v[44:47], a[200:203], v[192:195], v[44:47]
    v_mfma_f32_16x16x32_bf16 v[48:51], a[200:203], v[196:199], v[48:51]
    v_mfma_f32_16x16x32_bf16 v[52:55], a[200:203], v[200:203], v[52:55]
    v_mfma_f32_16x16x32_bf16 v[56:59], a[200:203], v[204:207], v[56:59]
    v_mfma_f32_16x16x32_bf16 v[60:63], a[204:207], v[192:195], v[60:63]
    v_mfma_f32_16x16x32_bf16 v[64:67], a[204:207], v[196:199], v[64:67]
    v_mfma_f32_16x16x32_bf16 v[68:71], a[204:207], v[200:203], v[68:71]
    v_mfma_f32_16x16x32_bf16 v[72:75], a[204:207], v[204:207], v[72:75]
    s_waitcnt vmcnt(0)
    v_mfma_f32_16x16x32_bf16 v[12:15], a[208:211], v[208:211], v[12:15]
    v_mfma_f32_16x16x32_bf16 v[16:19], a[208:211], v[212:215], v[16:19]
    v_mfma_f32_16x16x32_bf16 v[20:23], a[208:211], v[216:219], v[20:23]
    v_mfma_f32_16x16x32_bf16 v[24:27], a[208:211], v[220:223], v[24:27]
    v_mfma_f32_16x16x32_bf16 v[28:31], a[212:215], v[208:211], v[28:31]
    v_mfma_f32_16x16x32_bf16 v[32:35], a[212:215], v[212:215], v[32:35]
    v_mfma_f32_16x16x32_bf16 v[36:39], a[212:215], v[216:219], v[36:39]
    v_mfma_f32_16x16x32_bf16 v[40:43], a[212:215], v[220:223], v[40:43]
    v_mfma_f32_16x16x32_bf16 v[44:47], a[216:219], v[208:211], v[44:47]
    v_mfma_f32_16x16x32_bf16 v[48:51], a[216:219], v[212:215], v[48:51]
    v_mfma_f32_16x16x32_bf16 v[52:55], a[216:219], v[216:219], v[52:55]
    v_mfma_f32_16x16x32_bf16 v[56:59], a[216:219], v[220:223], v[56:59]
    v_mfma_f32_16x16x32_bf16 v[60:63], a[220:223], v[208:211], v[60:63]
    v_mfma_f32_16x16x32_bf16 v[64:67], a[220:223], v[212:215], v[64:67]
    v_mfma_f32_16x16x32_bf16 v[68:71], a[220:223], v[216:219], v[68:71]
    v_mfma_f32_16x16x32_bf16 v[72:75], a[220:223], v[220:223], v[72:75]
    s_lshl_b32 s30, s3, 14
    v_add_u32 v11, s30, v5
    s_lshl_b32 s30, s3, 12
    v_add_u32 v4, s30, v5
    s_cmp_eq_u32 s3, 1
    s_cbranch_scc1 ffn_kernel_xd14
    s_cmp_eq_u32 s3, 2
    s_cbranch_scc1 ffn_kernel_xd15
    s_cmp_eq_u32 s3, 3
    s_cbranch_scc1 ffn_kernel_xd16
    s_nop 7
    ds_write_b128 v11, v[28:31] offset:4096
    ds_write_b128 v11, v[32:35] offset:5120
    ds_write_b128 v11, v[36:39] offset:6144
    ds_write_b128 v11, v[40:43] offset:7168
    ds_write_b128 v11, v[44:47] offset:8192
    ds_write_b128 v11, v[48:51] offset:9216
    ds_write_b128 v11, v[52:55] offset:10240
    ds_write_b128 v11, v[56:59] offset:11264
    ds_write_b128 v11, v[60:63] offset:12288
    ds_write_b128 v11, v[64:67] offset:13312
    ds_write_b128 v11, v[68:71] offset:14336
    ds_write_b128 v11, v[72:75] offset:15360
    s_waitcnt lgkmcnt(0)
    s_barrier
    ds_read_b128 v[128:131], v4 offset:16384
    ds_read_b128 v[132:135], v4 offset:32768
    ds_read_b128 v[136:139], v4 offset:49152
    ds_read_b128 v[140:143], v4 offset:17408
    ds_read_b128 v[144:147], v4 offset:33792
    ds_read_b128 v[148:151], v4 offset:50176
    ds_read_b128 v[152:155], v4 offset:18432
    ds_read_b128 v[156:159], v4 offset:34816
    ds_read_b128 v[160:163], v4 offset:51200
    ds_read_b128 v[164:167], v4 offset:19456
    ds_read_b128 v[168:171], v4 offset:35840
    ds_read_b128 v[172:175], v4 offset:52224
    s_waitcnt lgkmcnt(9)
    v_pk_add_f32 v[128:129], v[128:129], v[132:133]
    v_pk_add_f32 v[136:137], v[136:137], v[12:13]
    v_pk_add_f32 v[128:129], v[128:129], v[136:137]
    v_pk_add_f32 v[130:131], v[130:131], v[134:135]
    v_pk_add_f32 v[138:139], v[138:139], v[14:15]
    v_pk_add_f32 v[130:131], v[130:131], v[138:139]
    s_waitcnt lgkmcnt(6)
    v_pk_add_f32 v[140:141], v[140:141], v[144:145]
    v_pk_add_f32 v[148:149], v[148:149], v[16:17]
    v_pk_add_f32 v[140:141], v[140:141], v[148:149]
    v_pk_add_f32 v[142:143], v[142:143], v[146:147]
    v_pk_add_f32 v[150:151], v[150:151], v[18:19]
    v_pk_add_f32 v[142:143], v[142:143], v[150:151]
    s_waitcnt lgkmcnt(3)
    v_pk_add_f32 v[152:153], v[152:153], v[156:157]
    v_pk_add_f32 v[160:161], v[160:161], v[20:21]
    v_pk_add_f32 v[152:153], v[152:153], v[160:161]
    v_pk_add_f32 v[154:155], v[154:155], v[158:159]
    v_pk_add_f32 v[162:163], v[162:163], v[22:23]
    v_pk_add_f32 v[154:155], v[154:155], v[162:163]
    s_waitcnt lgkmcnt(0)
    v_pk_add_f32 v[164:165], v[164:165], v[168:169]
    v_pk_add_f32 v[172:173], v[172:173], v[24:25]
    v_pk_add_f32 v[164:165], v[164:165], v[172:173]
    v_pk_add_f32 v[166:167], v[166:167], v[170:171]
    v_pk_add_f32 v[174:175], v[174:175], v[26:27]
    v_pk_add_f32 v[166:167], v[166:167], v[174:175]
    s_branch ffn_kernel_xd17
ffn_kernel_xd14:
    s_nop 7
    ds_write_b128 v11, v[12:15] offset:0
    ds_write_b128 v11, v[16:19] offset:1024
    ds_write_b128 v11, v[20:23] offset:2048
    ds_write_b128 v11, v[24:27] offset:3072
    ds_write_b128 v11, v[44:47] offset:8192
    ds_write_b128 v11, v[48:51] offset:9216
    ds_write_b128 v11, v[52:55] offset:10240
    ds_write_b128 v11, v[56:59] offset:11264
    ds_write_b128 v11, v[60:63] offset:12288
    ds_write_b128 v11, v[64:67] offset:13312
    ds_write_b128 v11, v[68:71] offset:14336
    ds_write_b128 v11, v[72:75] offset:15360
    s_waitcnt lgkmcnt(0)
    s_barrier
    ds_read_b128 v[128:131], v4 offset:0
    ds_read_b128 v[132:135], v4 offset:32768
    ds_read_b128 v[136:139], v4 offset:49152
    ds_read_b128 v[140:143], v4 offset:1024
    ds_read_b128 v[144:147], v4 offset:33792
    ds_read_b128 v[148:151], v4 offset:50176
    ds_read_b128 v[152:155], v4 offset:2048
    ds_read_b128 v[156:159], v4 offset:34816
    ds_read_b128 v[160:163], v4 offset:51200
    ds_read_b128 v[164:167], v4 offset:3072
    ds_read_b128 v[168:171], v4 offset:35840
    ds_read_b128 v[172:175], v4 offset:52224
    s_waitcnt lgkmcnt(9)
    v_pk_add_f32 v[128:129], v[128:129], v[132:133]
    v_pk_add_f32 v[136:137], v[136:137], v[28:29]
    v_pk_add_f32 v[128:129], v[128:129], v[136:137]
    v_pk_add_f32 v[130:131], v[130:131], v[134:135]
    v_pk_add_f32 v[138:139], v[138:139], v[30:31]
    v_pk_add_f32 v[130:131], v[130:131], v[138:139]
    s_waitcnt lgkmcnt(6)
    v_pk_add_f32 v[140:141], v[140:141], v[144:145]
    v_pk_add_f32 v[148:149], v[148:149], v[32:33]
    v_pk_add_f32 v[140:141], v[140:141], v[148:149]
    v_pk_add_f32 v[142:143], v[142:143], v[146:147]
    v_pk_add_f32 v[150:151], v[150:151], v[34:35]
    v_pk_add_f32 v[142:143], v[142:143], v[150:151]
    s_waitcnt lgkmcnt(3)
    v_pk_add_f32 v[152:153], v[152:153], v[156:157]
    v_pk_add_f32 v[160:161], v[160:161], v[36:37]
    v_pk_add_f32 v[152:153], v[152:153], v[160:161]
    v_pk_add_f32 v[154:155], v[154:155], v[158:159]
    v_pk_add_f32 v[162:163], v[162:163], v[38:39]
    v_pk_add_f32 v[154:155], v[154:155], v[162:163]
    s_waitcnt lgkmcnt(0)
    v_pk_add_f32 v[164:165], v[164:165], v[168:169]
    v_pk_add_f32 v[172:173], v[172:173], v[40:41]
    v_pk_add_f32 v[164:165], v[164:165], v[172:173]
    v_pk_add_f32 v[166:167], v[166:167], v[170:171]
    v_pk_add_f32 v[174:175], v[174:175], v[42:43]
    v_pk_add_f32 v[166:167], v[166:167], v[174:175]
    s_branch ffn_kernel_xd17
ffn_kernel_xd15:
    s_nop 7
    ds_write_b128 v11, v[12:15] offset:0
    ds_write_b128 v11, v[16:19] offset:1024
    ds_write_b128 v11, v[20:23] offset:2048
    ds_write_b128 v11, v[24:27] offset:3072
    ds_write_b128 v11, v[28:31] offset:4096
    ds_write_b128 v11, v[32:35] offset:5120
    ds_write_b128 v11, v[36:39] offset:6144
    ds_write_b128 v11, v[40:43] offset:7168
    ds_write_b128 v11, v[60:63] offset:12288
    ds_write_b128 v11, v[64:67] offset:13312
    ds_write_b128 v11, v[68:71] offset:14336
    ds_write_b128 v11, v[72:75] offset:15360
    s_waitcnt lgkmcnt(0)
    s_barrier
    ds_read_b128 v[128:131], v4 offset:0
    ds_read_b128 v[132:135], v4 offset:16384
    ds_read_b128 v[136:139], v4 offset:49152
    ds_read_b128 v[140:143], v4 offset:1024
    ds_read_b128 v[144:147], v4 offset:17408
    ds_read_b128 v[148:151], v4 offset:50176
    ds_read_b128 v[152:155], v4 offset:2048
    ds_read_b128 v[156:159], v4 offset:18432
    ds_read_b128 v[160:163], v4 offset:51200
    ds_read_b128 v[164:167], v4 offset:3072
    ds_read_b128 v[168:171], v4 offset:19456
    ds_read_b128 v[172:175], v4 offset:52224
    s_waitcnt lgkmcnt(9)
    v_pk_add_f32 v[128:129], v[128:129], v[132:133]
    v_pk_add_f32 v[136:137], v[136:137], v[44:45]
    v_pk_add_f32 v[128:129], v[128:129], v[136:137]
    v_pk_add_f32 v[130:131], v[130:131], v[134:135]
    v_pk_add_f32 v[138:139], v[138:139], v[46:47]
    v_pk_add_f32 v[130:131], v[130:131], v[138:139]
    s_waitcnt lgkmcnt(6)
    v_pk_add_f32 v[140:141], v[140:141], v[144:145]
    v_pk_add_f32 v[148:149], v[148:149], v[48:49]
    v_pk_add_f32 v[140:141], v[140:141], v[148:149]
    v_pk_add_f32 v[142:143], v[142:143], v[146:147]
    v_pk_add_f32 v[150:151], v[150:151], v[50:51]
    v_pk_add_f32 v[142:143], v[142:143], v[150:151]
    s_waitcnt lgkmcnt(3)
    v_pk_add_f32 v[152:153], v[152:153], v[156:157]
    v_pk_add_f32 v[160:161], v[160:161], v[52:53]
    v_pk_add_f32 v[152:153], v[152:153], v[160:161]
    v_pk_add_f32 v[154:155], v[154:155], v[158:159]
    v_pk_add_f32 v[162:163], v[162:163], v[54:55]
    v_pk_add_f32 v[154:155], v[154:155], v[162:163]
    s_waitcnt lgkmcnt(0)
    v_pk_add_f32 v[164:165], v[164:165], v[168:169]
    v_pk_add_f32 v[172:173], v[172:173], v[56:57]
    v_pk_add_f32 v[164:165], v[164:165], v[172:173]
    v_pk_add_f32 v[166:167], v[166:167], v[170:171]
    v_pk_add_f32 v[174:175], v[174:175], v[58:59]
    v_pk_add_f32 v[166:167], v[166:167], v[174:175]
    s_branch ffn_kernel_xd17
ffn_kernel_xd16:
    s_nop 7
    ds_write_b128 v11, v[12:15] offset:0
    ds_write_b128 v11, v[16:19] offset:1024
    ds_write_b128 v11, v[20:23] offset:2048
    ds_write_b128 v11, v[24:27] offset:3072
    ds_write_b128 v11, v[28:31] offset:4096
    ds_write_b128 v11, v[32:35] offset:5120
    ds_write_b128 v11, v[36:39] offset:6144
    ds_write_b128 v11, v[40:43] offset:7168
    ds_write_b128 v11, v[44:47] offset:8192
    ds_write_b128 v11, v[48:51] offset:9216
    ds_write_b128 v11, v[52:55] offset:10240
    ds_write_b128 v11, v[56:59] offset:11264
    s_waitcnt lgkmcnt(0)
    s_barrier
    ds_read_b128 v[128:131], v4 offset:0
    ds_read_b128 v[132:135], v4 offset:16384
    ds_read_b128 v[136:139], v4 offset:32768
    ds_read_b128 v[140:143], v4 offset:1024
    ds_read_b128 v[144:147], v4 offset:17408
    ds_read_b128 v[148:151], v4 offset:33792
    ds_read_b128 v[152:155], v4 offset:2048
    ds_read_b128 v[156:159], v4 offset:18432
    ds_read_b128 v[160:163], v4 offset:34816
    ds_read_b128 v[164:167], v4 offset:3072
    ds_read_b128 v[168:171], v4 offset:19456
    ds_read_b128 v[172:175], v4 offset:35840
    s_waitcnt lgkmcnt(9)
    v_pk_add_f32 v[128:129], v[128:129], v[132:133]
    v_pk_add_f32 v[136:137], v[136:137], v[60:61]
    v_pk_add_f32 v[128:129], v[128:129], v[136:137]
    v_pk_add_f32 v[130:131], v[130:131], v[134:135]
    v_pk_add_f32 v[138:139], v[138:139], v[62:63]
    v_pk_add_f32 v[130:131], v[130:131], v[138:139]
    s_waitcnt lgkmcnt(6)
    v_pk_add_f32 v[140:141], v[140:141], v[144:145]
    v_pk_add_f32 v[148:149], v[148:149], v[64:65]
    v_pk_add_f32 v[140:141], v[140:141], v[148:149]
    v_pk_add_f32 v[142:143], v[142:143], v[146:147]
    v_pk_add_f32 v[150:151], v[150:151], v[66:67]
    v_pk_add_f32 v[142:143], v[142:143], v[150:151]
    s_waitcnt lgkmcnt(3)
    v_pk_add_f32 v[152:153], v[152:153], v[156:157]
    v_pk_add_f32 v[160:161], v[160:161], v[68:69]
    v_pk_add_f32 v[152:153], v[152:153], v[160:161]
    v_pk_add_f32 v[154:155], v[154:155], v[158:159]
    v_pk_add_f32 v[162:163], v[162:163], v[70:71]
    v_pk_add_f32 v[154:155], v[154:155], v[162:163]
    s_waitcnt lgkmcnt(0)
    v_pk_add_f32 v[164:165], v[164:165], v[168:169]
    v_pk_add_f32 v[172:173], v[172:173], v[72:73]
    v_pk_add_f32 v[164:165], v[164:165], v[172:173]
    v_pk_add_f32 v[166:167], v[166:167], v[170:171]
    v_pk_add_f32 v[174:175], v[174:175], v[74:75]
    v_pk_add_f32 v[166:167], v[166:167], v[174:175]
ffn_kernel_xd17:
    s_barrier
    v_accvgpr_read_b32 v76, a224
    v_accvgpr_read_b32 v77, a225
    v_accvgpr_read_b32 v78, a226
    v_accvgpr_read_b32 v79, a227
    v_accvgpr_read_b32 v80, a228
    v_accvgpr_read_b32 v81, a229
    v_accvgpr_read_b32 v82, a230
    v_accvgpr_read_b32 v83, a231
    v_cvt_pk_bf16_f32 v136, v128, v129
    v_cvt_pk_bf16_f32 v137, v130, v131
    v_lshlrev_b32 v128, 16, v136
    v_and_b32 v129, 0xffff0000, v136
    v_lshlrev_b32 v132, 16, v76
    v_and_b32 v133, 0xffff0000, v76
    v_pk_add_f32 v[128:129], v[128:129], v[132:133]
    v_cvt_pk_bf16_f32 v136, v128, v129
    v_lshlrev_b32 v130, 16, v137
    v_and_b32 v131, 0xffff0000, v137
    v_lshlrev_b32 v134, 16, v77
    v_and_b32 v135, 0xffff0000, v77
    v_pk_add_f32 v[130:131], v[130:131], v[134:135]
    v_cvt_pk_bf16_f32 v137, v130, v131
    v_cvt_pk_bf16_f32 v148, v140, v141
    v_cvt_pk_bf16_f32 v149, v142, v143
    v_lshlrev_b32 v140, 16, v148
    v_and_b32 v141, 0xffff0000, v148
    v_lshlrev_b32 v144, 16, v78
    v_and_b32 v145, 0xffff0000, v78
    v_pk_add_f32 v[140:141], v[140:141], v[144:145]
    v_cvt_pk_bf16_f32 v148, v140, v141
    v_lshlrev_b32 v142, 16, v149
    v_and_b32 v143, 0xffff0000, v149
    v_lshlrev_b32 v146, 16, v79
    v_and_b32 v147, 0xffff0000, v79
    v_pk_add_f32 v[142:143], v[142:143], v[146:147]
    v_cvt_pk_bf16_f32 v149, v142, v143
    v_cvt_pk_bf16_f32 v160, v152, v153
    v_cvt_pk_bf16_f32 v161, v154, v155
    v_lshlrev_b32 v152, 16, v160
    v_and_b32 v153, 0xffff0000, v160
    v_lshlrev_b32 v156, 16, v80
    v_and_b32 v157, 0xffff0000, v80
    v_pk_add_f32 v[152:153], v[152:153], v[156:157]
    v_cvt_pk_bf16_f32 v160, v152, v153
    v_lshlrev_b32 v154, 16, v161
    v_and_b32 v155, 0xffff0000, v161
    v_lshlrev_b32 v158, 16, v81
    v_and_b32 v159, 0xffff0000, v81
    v_pk_add_f32 v[154:155], v[154:155], v[158:159]
    v_cvt_pk_bf16_f32 v161, v154, v155
    v_cvt_pk_bf16_f32 v172, v164, v165
    v_cvt_pk_bf16_f32 v173, v166, v167
    v_lshlrev_b32 v164, 16, v172
    v_and_b32 v165, 0xffff0000, v172
    v_lshlrev_b32 v168, 16, v82
    v_and_b32 v169, 0xffff0000, v82
    v_pk_add_f32 v[164:165], v[164:165], v[168:169]
    v_cvt_pk_bf16_f32 v172, v164, v165
    v_lshlrev_b32 v166, 16, v173
    v_and_b32 v167, 0xffff0000, v173
    v_lshlrev_b32 v170, 16, v83
    v_and_b32 v171, 0xffff0000, v83
    v_pk_add_f32 v[166:167], v[166:167], v[170:171]
    v_cvt_pk_bf16_f32 v173, v166, v167
    s_add_u32 s28, s34, 0
    buffer_store_dwordx2 v[136:137], v7, s[80:83], s28 offen
    s_add_u32 s28, s34, 14336
    buffer_store_dwordx2 v[148:149], v7, s[80:83], s28 offen
    s_add_u32 s28, s34, 28672
    buffer_store_dwordx2 v[160:161], v7, s[80:83], s28 offen
    s_add_u32 s28, s34, 43008
    buffer_store_dwordx2 v[172:173], v7, s[80:83], s28 offen
    s_mul_i32 s34, s33, 57344
    s_lshl_b32 s35, s31, 7
    s_add_u32 s34, s34, s35
    s_lshl_b32 s35, s3, 5
    s_add_u32 s34, s34, s35
    v_mul_u32_u24 v8, 896, v3
    v_lshl_add_u32 v8, v2, 3, v8
    s_add_u32 s28, s34, 0
    buffer_store_dwordx2 v[136:137], v8, s[88:91], s28 offen
    s_add_u32 s28, s34, 14336
    buffer_store_dwordx2 v[148:149], v8, s[88:91], s28 offen
    s_add_u32 s28, s34, 28672
    buffer_store_dwordx2 v[160:161], v8, s[88:91], s28 offen
    s_add_u32 s28, s34, 43008
    buffer_store_dwordx2 v[172:173], v8, s[88:91], s28 offen
    s_waitcnt vmcnt(0)
ffn_kernel_done:
    s_endpgm
.section .rodata,"a"
.p2align 6
.amdhsa_kernel prep_kernel
  .amdhsa_next_free_vgpr 96
  .amdhsa_next_free_sgpr 96
  .amdhsa_accum_offset 96
  .amdhsa_group_segment_fixed_size 0
  .amdhsa_kernarg_size 80
  .amdhsa_user_sgpr_count 2
  .amdhsa_user_sgpr_kernarg_segment_ptr 1
  .amdhsa_system_sgpr_workgroup_id_x 1
.end_amdhsa_kernel
.p2align 6
.amdhsa_kernel qa_kernel
  .amdhsa_next_free_vgpr 256
  .amdhsa_next_free_sgpr 100
  .amdhsa_accum_offset 256
  .amdhsa_group_segment_fixed_size 0
  .amdhsa_kernarg_size 80
  .amdhsa_user_sgpr_count 2
  .amdhsa_user_sgpr_kernarg_segment_ptr 1
  .amdhsa_system_sgpr_workgroup_id_x 1
.end_amdhsa_kernel
.p2align 6
.amdhsa_kernel ffn_kernel
  .amdhsa_next_free_vgpr 488
  .amdhsa_next_free_sgpr 100
  .amdhsa_accum_offset 256
  .amdhsa_group_segment_fixed_size 0
  .amdhsa_kernarg_size 80
  .amdhsa_user_sgpr_count 2
  .amdhsa_user_sgpr_kernarg_segment_ptr 1
  .amdhsa_system_sgpr_workgroup_id_x 1
.end_amdhsa_kernel
```
